```python
import torch

def _softmax(x, axis=-1):
    return torch.softmax(x, dim=axis)
def _gelu(x):
    return torch.nn.functional.gelu(x, approximate="tanh")
def _silu(x):
    return torch.nn.functional.silu(x)
def _sigmoid(x):
    return torch.sigmoid(x)
def _layernorm(x, axis=-1, eps=1e-5):
    m = x.mean(dim=axis, keepdim=True)
    v = x.var(dim=axis, keepdim=True, unbiased=False)
    return (x - m) / torch.sqrt(v + eps)
def _scatter_add(tgt, idx, src, axis=0):
    return tgt.clone().index_add_(axis, idx, src)
def _segment_sum(src, seg, n):
    out = torch.zeros((n,) + src.shape[1:], dtype=src.dtype)
    return out.index_add_(0, seg, src)
def _pad(x, pw):
    flat = tuple(v for pair in reversed(pw) for v in pair)
    return torch.nn.functional.pad(x, flat)

kernel_name = 'gated_mix__linear_attn_block__spectral_gfnet__prompt'

def setup_inputs():

    _w = (lambda a: (lambda t: t.to(torch.bfloat16) if t.is_floating_point() else t)(torch.as_tensor(a)))
    def _A_setup():
        B, S, D = 1, 2048, 512
        return {
            "x": _w((lambda *s: torch.randn(*s, dtype=torch.bfloat16) * 0.05)(B, S, D)),
            "wqkv": _w((lambda *s: torch.randn(*s, dtype=torch.bfloat16) * 0.4)(D, 3 * D)),
            "wo": _w((lambda *s: torch.randn(*s, dtype=torch.bfloat16) * 0.05)(D, D)),
        }
    _A_in = _A_setup()

    def _B_setup():
        B, S, D = 1, 2048, 512
        Df = D // 2 + 1
        return {
            "x": _w((lambda *s: torch.randn(*s, dtype=torch.bfloat16) * 0.05)(B, S, D)),
            "w_r": _w((lambda *s: torch.randn(*s, dtype=torch.bfloat16) * 1.6)(S, Df) * 0.02),
            "w_i": _w((lambda *s: torch.randn(*s, dtype=torch.bfloat16) * 1.6)(S, Df) * 0.02),
        }
    _B_in = _B_setup()

    return {
        "A_x": _A_in["x"],
        "A_wqkv": _A_in["wqkv"],
        "A_wo": _A_in["wo"],
        "B_x": _B_in["x"],
        "B_w_r": _B_in["w_r"],
        "B_w_i": _B_in["w_i"],
        "gate_w": _w((lambda *s: torch.randn(*s, dtype=torch.bfloat16) * 0.05)(512) * 16.0),
    }

def reference(A_x, A_wqkv, A_wo, B_x, B_w_r, B_w_i, gate_w):
    def _A_ref(x, wqkv, wo):
        B, S, D = x.shape
        H = 32; Dh = D // H
        qkv = (lambda x, *d: x.permute(*d))((x @ wqkv).reshape(B, S, 3, H, Dh), 2, 0, 3, 1, 4)
        q, k, v = qkv[0], qkv[1], qkv[2]
        phi = lambda t: torch.where(t > 0, t + 1, torch.exp(t)) + 1e-6
        pq, pk = phi(q), phi(k)
        kv = torch.einsum("bhsd,bhse->bhde", pk, v)
        z = torch.einsum("bhsd->bhd", pk)
        num = torch.einsum("bhqd,bhde->bhqe", pq, kv)
        den = torch.einsum("bhqd,bhd->bhq", pq, z)[..., None] + 1e-6
        o = num / den
        return (lambda x, *d: x.permute(*d))(o, 0, 2, 1, 3).reshape(B, S, D) @ wo

    def _B_ref(x, w_r, w_i):
        B, S, D = x.shape
        X = (lambda x, axes=(-2,-1): torch.fft.rfft2(x.float(), dim=axes))(x, axes=(-2, -1))
        W = w_r + 1j * w_i
        X = X * W
        y = (lambda x, s, axes=(-2,-1): torch.fft.irfft2(x, s=s, dim=axes).to(torch.bfloat16))(X, (S, D), axes=(-2, -1))
        return y

    x = A_x
    g = _sigmoid((x * gate_w).sum(-1, keepdims=True))
    a = _A_ref(x, A_wqkv, A_wo)
    b = _B_ref(x, B_w_r, B_w_i)
    return g * a + (1 - g) * b
```

```asm
; @launch kernel=k1_kernel grid=(256,1,1) block=(512,1,1) lds=151616
; @launch kernel=k2_kernel grid=(449,1,1) block=(256,1,1) lds=32768
; @launch kernel=k3_kernel grid=(256,1,1) block=(256,1,1) lds=131072
.amdgcn_target "amdgcn-amd-amdhsa--gfx950"
.text
.globl k1_kernel
.p2align 8
.type k1_kernel,@function
k1_kernel:
    s_cmp_ge_u32 s2, 256
    s_cbranch_scc1 k1_end
    s_load_dwordx4 s[4:7], s[0:1], 0
    s_load_dwordx4 s[8:11], s[0:1], 32
    s_load_dwordx2 s[14:15], s[0:1], 72
    s_load_dwordx2 s[60:61], s[0:1], 16
    s_load_dwordx2 s[12:13], s[0:1], 48
    v_and_b32 v1, 63, v0
    v_lshrrev_b32 v2, 6, v0
    s_and_b32 s36, s2, 7
    s_lshr_b32 s37, s2, 3
    v_readfirstlane_b32 s54, v2
    s_and_b32 s38, s36, 1
    s_lshl_b32 s38, s38, 3
    s_and_b32 s45, s37, 7
    s_add_u32 s38, s38, s45
    s_lshr_b32 s39, s37, 3
    s_lshr_b32 s36, s36, 1
    s_and_b32 s40, s54, 3
    s_cmp_lt_u32 s54, 4
    s_cbranch_scc1 k1_compute
    s_setprio 3
    s_getpc_b64 s[24:25]
    s_add_u32 s24, s24, k1_kernel@rel32@lo+4
    s_addc_u32 s25, s25, k1_kernel@rel32@hi+12
    s_mov_b32 s26, (k2_kernel-k1_kernel)
    s_mov_b32 s27, 0x00020000
    v_and_b32 v2, 255, v0
    v_lshlrev_b32 v2, 6, v2
    buffer_load_dword v100, v2, s[24:27], 0 offen
    s_lshl_b32 s43, s40, 12
    s_add_u32 s44, s43, 16384
    v_lshrrev_b32 v2, 3, v1
    v_and_b32 v3, 7, v1
    v_lshrrev_b32 v4, 4, v1
    v_xor_b32 v3, v3, v4
    v_lshlrev_b32 v3, 4, v3
    v_and_b32 v5, 15, v1
    v_lshlrev_b32 v6, 2, v4
    v_xor_b32 v5, v5, v6
    s_lshl_b32 s45, s40, 5
    v_add_u32 v8, s45, v2
    v_lshl_add_u32 v8, v8, 10, v3
    v_xor_b32 v9, 64, v8
    v_add_u32 v10, 14336, v8
    v_add_u32 v11, 21504, v9
    v_add_u32 v9, 7168, v9
    s_lshl_b32 s41, s38, 17
    s_getpc_b64 s[20:21]
    s_add_u32 s20, s20, tab_F@rel32@lo+4
    s_addc_u32 s21, s21, tab_F@rel32@hi+12
    s_mov_b32 s22, 524288
    s_mov_b32 s23, 0x00020000
    s_cmp_eq_u32 s36, 3
    s_movk_i32 s48, 1024
    s_cselect_b32 s48, s48, 3072
    v_mul_lo_u32 v12, s48, v4
    s_lshl_b32 s42, s39, 8
    v_lshlrev_b32 v6, 4, v5
    s_sub_u32 s45, s36, 1
    s_cmp_lt_u32 s45, 2
    s_cbranch_scc0 k1_ld_notkv
    v_and_b32 v6, 3, v5
    v_lshlrev_b32 v6, 4, v6
    v_and_b32 v2, 4, v5
    v_lshl_add_u32 v6, v2, 8, v6
    v_and_b32 v2, 8, v5
    v_lshl_add_u32 v6, v2, 3, v6
    s_lshl_b32 s45, s45, 2
    s_add_u32 s45, s39, s45
    s_lshl_b32 s42, s45, 7
    s_add_u32 s42, s42, 1024
k1_ld_notkv:
    v_add_u32 v12, v12, v6
    s_lshl_b32 s45, s48, 4
    s_mul_i32 s45, s45, s40
    s_add_u32 s42, s42, s45
    s_lshl_b32 s55, s48, 2
    s_sub_u32 s55, s55, 1024
    s_lshl_b32 s57, s48, 6
    s_and_b32 s56, s37, 7
    s_lshr_b32 s45, s37, 3
    s_lshl_b32 s45, s45, 1
    s_add_u32 s56, s56, s45
    s_lshr_b32 s45, s37, 3
    s_xor_b32 s56, s37, s45
    s_and_b32 s56, s56, 1
    s_lshl_b32 s56, s56, 2
    s_waitcnt lgkmcnt(0)
    s_mov_b32 s16, s4
    s_mov_b32 s17, s5
    s_mov_b32 s18, 2097152
    s_mov_b32 s19, 0x00020000
    s_cmp_eq_u32 s36, 3
    s_cselect_b32 s20, s20, s6
    s_cselect_b32 s21, s21, s7
    s_cselect_b32 s22, s22, 1572864
    s_add_u32 s46, s56, 0
    s_and_b32 s46, s46, 7
    s_add_u32 m0, s43, 0
    s_lshl_b32 s45, s46, 7
    s_add_u32 s45, s41, s45
    buffer_load_dwordx4 v8, s[16:19], s45 offen offset:0 lds
    buffer_load_dwordx4 v9, s[16:19], s45 offen offset:1024 lds
    buffer_load_dwordx4 v10, s[16:19], s45 offen offset:2048 lds
    buffer_load_dwordx4 v11, s[16:19], s45 offen offset:3072 lds
    s_add_u32 m0, s44, 0
    s_mul_i32 s46, s46, s57
    s_add_u32 s46, s46, s42
    buffer_load_dwordx4 v12, s[20:23], s46 offen offset:0 lds
    s_add_u32 s46, s46, s55
    buffer_load_dwordx4 v12, s[20:23], s46 offen offset:1024 lds
    s_add_u32 s46, s46, s55
    buffer_load_dwordx4 v12, s[20:23], s46 offen offset:2048 lds
    s_add_u32 s46, s46, s55
    buffer_load_dwordx4 v12, s[20:23], s46 offen offset:3072 lds
    s_mov_b32 s24, s8
    s_mov_b32 s25, s9
    s_mov_b32 s26, 1052672
    s_mov_b32 s27, 0x00020000
    s_mov_b32 s28, s10
    s_mov_b32 s29, s11
    s_mov_b32 s30, 1052672
    s_mov_b32 s31, 0x00020000
    s_mov_b32 s32, s14
    s_mov_b32 s33, s15
    s_mov_b32 s34, 16777216
    s_mov_b32 s35, 0x00020000
    s_mov_b32 s62, 524288
    s_mov_b32 s63, 0x00020000
    s_mov_b32 s14, 1024
    s_mov_b32 s15, 0x00020000
    s_mov_b32 s52, 0x3fb8aa3b
    s_and_b32 s45, s2, 7
    s_bfe_u32 s46, s2, 0x30003
    s_lshr_b32 s47, s2, 6
    s_lshl_b32 s58, s47, 6
    s_add_u32 s58, s58, s46
    s_mul_i32 s58, s58, 4112
    s_lshl_b32 s48, s45, 6
    s_add_u32 s58, s58, s48
    s_lshr_b32 s51, s46, 1
    s_lshl_b32 s51, s51, 11
    s_lshl_b32 s47, s47, 8
    s_add_u32 s51, s51, s47
    s_and_b32 s46, s46, 1
    s_lshl_b32 s46, s46, 7
    s_add_u32 s51, s51, s46
    s_lshl_b32 s46, s40, 5
    s_add_u32 s51, s51, s46
    s_add_u32 s51, s51, 6291456
    s_lshl_b32 s48, s45, 18
    s_mul_i32 s7, s40, 5120
    s_add_u32 s7, s7, 131136
    s_lshl_b32 s46, s40, 1
    v_add_u32 v2, 0, v1
    v_mul_u32_u24 v3, 205, v2
    v_lshrrev_b32 v3, 10, v3
    v_mul_u32_u24 v4, 5, v3
    v_sub_u32 v4, v2, v4
    v_and_b32 v5, 1, v3
    v_add_u32 v5, s46, v5
    v_lshrrev_b32 v3, 1, v3
    v_lshl_add_u32 v5, v3, 6, v5
    v_mul_u32_u24 v5, 514, v5
    v_and_b32 v5, -16, v5
    v_lshl_add_u32 v34, v4, 4, v5
    v_add_u32 v2, 64, v1
    v_mul_u32_u24 v3, 205, v2
    v_lshrrev_b32 v3, 10, v3
    v_mul_u32_u24 v4, 5, v3
    v_sub_u32 v4, v2, v4
    v_and_b32 v5, 1, v3
    v_add_u32 v5, s46, v5
    v_lshrrev_b32 v3, 1, v3
    v_lshl_add_u32 v5, v3, 6, v5
    v_mul_u32_u24 v5, 514, v5
    v_and_b32 v5, -16, v5
    v_lshl_add_u32 v35, v4, 4, v5
    v_subrev_u32 v35, 1024, v35
    v_lshrrev_b32 v2, 4, v1
    v_min_u32 v2, 1, v2
    v_lshl_add_u32 v35, v2, 30, v35
    v_and_b32 v2, 31, v1
    v_lshrrev_b32 v3, 5, v1
    v_mul_u32_u24 v4, 82, v3
    v_lshl_add_u32 v36, v2, 1, v4
    s_lshl_b32 s46, s40, 2
    s_add_u32 s46, s46, s7
    v_add_u32 v36, s46, v36
    v_lshlrev_b32 v37, 13, v2
    v_lshl_add_u32 v37, v3, 4, v37
    v_add_u32 v37, s48, v37
    v_bfe_u32 v2, v1, 3, 1
    v_and_b32 v3, 7, v1
    v_mul_u32_u24 v4, 160, v3
    v_mul_u32_u24 v5, 82, v2
    v_add3_u32 v38, v4, v5, s46
    v_and_b32 v2, 15, v1
    v_lshlrev_b32 v39, 1, v2
    v_add_u32 v39, 2097152, v39
    v_lshrrev_b32 v2, 4, v1
    v_min_u32 v2, 1, v2
    v_lshl_add_u32 v39, v2, 30, v39
    s_cmp_eq_u32 s45, 7
    s_cselect_b32 s59, s51, 1073741824
    v_lshlrev_b32 v2, 4, v1
    v_lshrrev_b32 v3, 2, v1
    v_and_b32 v4, 3, v1
    v_lshlrev_b32 v4, 4, v4
    v_lshl_add_u32 v40, v3, 10, v4
    v_bfe_u32 v3, v1, 3, 2
    v_lshlrev_b32 v3, 2, v3
    v_bfe_u32 v4, v1, 2, 1
    v_lshl_add_u32 v3, v4, 4, v3
    v_and_b32 v4, 3, v1
    v_add_u32 v3, v3, v4
    v_lshlrev_b32 v3, 1, v3
    v_lshrrev_b32 v4, 5, v1
    v_lshl_add_u32 v3, v4, 8, v3
    v_add_u32 v41, s7, v3
    s_lshl_b32 s45, s2, 1
    s_add_u32 s45, s45, s40
    s_lshr_b32 s5, s45, 4
    s_lshl_b32 s5, s5, 14
    s_and_b32 s47, s45, 15
    s_lshl_b32 s47, s47, 6
    s_add_u32 s5, s5, s47
    s_lshl_b32 s6, s45, 10
    s_add_u32 s6, s6, 13631488
    s_cmp_lt_u32 s40, 2
    s_cselect_b32 s5, s5, 1073741824
    s_cselect_b32 s6, s6, 1073741824
    v_lshlrev_b32 v4, 7, v1
    s_getpc_b64 s[8:9]
    s_add_u32 s8, s8, k2_kernel@rel32@lo+4
    s_addc_u32 s9, s9, k2_kernel@rel32@hi+12
    s_mov_b32 s10, (k3_code_end-k2_kernel)
    s_mov_b32 s11, 0x00020000
    v_and_b32 v5, 255, v0
    v_lshlrev_b32 v5, 6, v5
    s_add_u32 s46, s56, 1
    s_and_b32 s46, s46, 7
    s_add_u32 m0, s43, 32768
    s_lshl_b32 s45, s46, 7
    s_add_u32 s45, s41, s45
    buffer_load_dwordx4 v8, s[16:19], s45 offen offset:0 lds
    buffer_load_dwordx4 v9, s[16:19], s45 offen offset:1024 lds
    buffer_load_dwordx4 v10, s[16:19], s45 offen offset:2048 lds
    buffer_load_dwordx4 v11, s[16:19], s45 offen offset:3072 lds
    s_waitcnt vmcnt(4)
    s_barrier
    s_add_u32 s46, s56, 1
    s_and_b32 s46, s46, 7
    s_add_u32 m0, s44, 32768
    s_mul_i32 s46, s46, s57
    s_add_u32 s46, s46, s42
    buffer_load_dwordx4 v12, s[20:23], s46 offen offset:0 lds
    s_add_u32 s46, s46, s55
    buffer_load_dwordx4 v12, s[20:23], s46 offen offset:1024 lds
    s_add_u32 s46, s46, s55
    buffer_load_dwordx4 v12, s[20:23], s46 offen offset:2048 lds
    s_add_u32 s46, s46, s55
    buffer_load_dwordx4 v12, s[20:23], s46 offen offset:3072 lds
    s_add_u32 s46, s56, 2
    s_and_b32 s46, s46, 7
    s_add_u32 m0, s43, 65536
    s_lshl_b32 s45, s46, 7
    s_add_u32 s45, s41, s45
    buffer_load_dwordx4 v8, s[16:19], s45 offen offset:0 lds
    buffer_load_dwordx4 v9, s[16:19], s45 offen offset:1024 lds
    buffer_load_dwordx4 v10, s[16:19], s45 offen offset:2048 lds
    buffer_load_dwordx4 v11, s[16:19], s45 offen offset:3072 lds
    s_add_u32 m0, s44, 65536
    s_mul_i32 s46, s46, s57
    s_add_u32 s46, s46, s42
    buffer_load_dwordx4 v12, s[20:23], s46 offen offset:0 lds
    s_add_u32 s46, s46, s55
    buffer_load_dwordx4 v12, s[20:23], s46 offen offset:1024 lds
    s_add_u32 s46, s46, s55
    buffer_load_dwordx4 v12, s[20:23], s46 offen offset:2048 lds
    s_add_u32 s46, s46, s55
    buffer_load_dwordx4 v12, s[20:23], s46 offen offset:3072 lds
    s_waitcnt vmcnt(8)
    s_barrier
    s_add_u32 s46, s56, 3
    s_and_b32 s46, s46, 7
    s_add_u32 m0, s43, 98304
    s_lshl_b32 s45, s46, 7
    s_add_u32 s45, s41, s45
    buffer_load_dwordx4 v8, s[16:19], s45 offen offset:0 lds
    buffer_load_dwordx4 v9, s[16:19], s45 offen offset:1024 lds
    buffer_load_dwordx4 v10, s[16:19], s45 offen offset:2048 lds
    buffer_load_dwordx4 v11, s[16:19], s45 offen offset:3072 lds
    s_add_u32 m0, s44, 98304
    s_mul_i32 s46, s46, s57
    s_add_u32 s46, s46, s42
    buffer_load_dwordx4 v12, s[20:23], s46 offen offset:0 lds
    s_add_u32 s46, s46, s55
    buffer_load_dwordx4 v12, s[20:23], s46 offen offset:1024 lds
    s_add_u32 s46, s46, s55
    buffer_load_dwordx4 v12, s[20:23], s46 offen offset:2048 lds
    s_add_u32 s46, s46, s55
    buffer_load_dwordx4 v12, s[20:23], s46 offen offset:3072 lds
    s_waitcnt vmcnt(8)
    s_barrier
    s_add_u32 s46, s56, 4
    s_and_b32 s46, s46, 7
    s_add_u32 m0, s43, 0
    s_lshl_b32 s45, s46, 7
    s_add_u32 s45, s41, s45
    buffer_load_dwordx4 v8, s[16:19], s45 offen offset:0 lds
    buffer_load_dwordx4 v9, s[16:19], s45 offen offset:1024 lds
    buffer_load_dwordx4 v10, s[16:19], s45 offen offset:2048 lds
    buffer_load_dwordx4 v11, s[16:19], s45 offen offset:3072 lds
    s_add_u32 m0, s44, 0
    s_mul_i32 s46, s46, s57
    s_add_u32 s46, s46, s42
    buffer_load_dwordx4 v12, s[20:23], s46 offen offset:0 lds
    s_add_u32 s46, s46, s55
    buffer_load_dwordx4 v12, s[20:23], s46 offen offset:1024 lds
    s_add_u32 s46, s46, s55
    buffer_load_dwordx4 v12, s[20:23], s46 offen offset:2048 lds
    s_add_u32 s46, s46, s55
    buffer_load_dwordx4 v12, s[20:23], s46 offen offset:3072 lds
    s_waitcnt vmcnt(8)
    s_barrier
    s_add_u32 s46, s56, 5
    s_and_b32 s46, s46, 7
    s_add_u32 m0, s43, 32768
    s_lshl_b32 s45, s46, 7
    s_add_u32 s45, s41, s45
    buffer_load_dwordx4 v8, s[16:19], s45 offen offset:0 lds
    buffer_load_dwordx4 v9, s[16:19], s45 offen offset:1024 lds
    buffer_load_dwordx4 v10, s[16:19], s45 offen offset:2048 lds
    buffer_load_dwordx4 v11, s[16:19], s45 offen offset:3072 lds
    s_add_u32 m0, s44, 32768
    s_mul_i32 s46, s46, s57
    s_add_u32 s46, s46, s42
    buffer_load_dwordx4 v12, s[20:23], s46 offen offset:0 lds
    s_add_u32 s46, s46, s55
    buffer_load_dwordx4 v12, s[20:23], s46 offen offset:1024 lds
    s_add_u32 s46, s46, s55
    buffer_load_dwordx4 v12, s[20:23], s46 offen offset:2048 lds
    s_add_u32 s46, s46, s55
    buffer_load_dwordx4 v12, s[20:23], s46 offen offset:3072 lds
    s_waitcnt vmcnt(8)
    s_barrier
    s_add_u32 s46, s56, 6
    s_and_b32 s46, s46, 7
    s_add_u32 m0, s43, 65536
    s_lshl_b32 s45, s46, 7
    s_add_u32 s45, s41, s45
    buffer_load_dwordx4 v8, s[16:19], s45 offen offset:0 lds
    buffer_load_dwordx4 v9, s[16:19], s45 offen offset:1024 lds
    buffer_load_dwordx4 v10, s[16:19], s45 offen offset:2048 lds
    buffer_load_dwordx4 v11, s[16:19], s45 offen offset:3072 lds
    s_add_u32 m0, s44, 65536
    s_mul_i32 s46, s46, s57
    s_add_u32 s46, s46, s42
    buffer_load_dwordx4 v12, s[20:23], s46 offen offset:0 lds
    s_add_u32 s46, s46, s55
    buffer_load_dwordx4 v12, s[20:23], s46 offen offset:1024 lds
    s_add_u32 s46, s46, s55
    buffer_load_dwordx4 v12, s[20:23], s46 offen offset:2048 lds
    s_add_u32 s46, s46, s55
    buffer_load_dwordx4 v12, s[20:23], s46 offen offset:3072 lds
    s_waitcnt vmcnt(8)
    s_barrier
    s_add_u32 s46, s56, 7
    s_and_b32 s46, s46, 7
    s_add_u32 m0, s43, 98304
    s_lshl_b32 s45, s46, 7
    s_add_u32 s45, s41, s45
    buffer_load_dwordx4 v8, s[16:19], s45 offen offset:0 lds
    buffer_load_dwordx4 v9, s[16:19], s45 offen offset:1024 lds
    buffer_load_dwordx4 v10, s[16:19], s45 offen offset:2048 lds
    buffer_load_dwordx4 v11, s[16:19], s45 offen offset:3072 lds
    s_add_u32 m0, s44, 98304
    s_mul_i32 s46, s46, s57
    s_add_u32 s46, s46, s42
    buffer_load_dwordx4 v12, s[20:23], s46 offen offset:0 lds
    s_add_u32 s46, s46, s55
    buffer_load_dwordx4 v12, s[20:23], s46 offen offset:1024 lds
    s_add_u32 s46, s46, s55
    buffer_load_dwordx4 v12, s[20:23], s46 offen offset:2048 lds
    s_add_u32 s46, s46, s55
    buffer_load_dwordx4 v12, s[20:23], s46 offen offset:3072 lds
    s_waitcnt vmcnt(8)
    s_barrier
    s_add_u32 m0, s7, 0
    s_nop 0
    buffer_load_dwordx4 v34, s[24:27], s58 offen lds
    buffer_load_dwordx4 v35, s[24:27], s58 offen offset:1024 lds
    s_add_u32 m0, s7, 2048
    s_nop 0
    buffer_load_dwordx4 v34, s[28:31], s58 offen lds
    buffer_load_dwordx4 v35, s[28:31], s58 offen offset:1024 lds
    s_add_u32 m0, s7, 4096
    s_nop 0
    buffer_load_dwordx4 v40, s[60:63], s5 offen lds
    buffer_load_dword v101, v5, s[8:11], 0 offen
    s_waitcnt vmcnt(6)
    s_barrier
    s_waitcnt vmcnt(1)
    ds_read_u16 v16, v36 offset:0
    ds_read_u16 v17, v36 offset:160
    ds_read_u16 v18, v36 offset:320
    ds_read_u16 v19, v36 offset:480
    ds_read_u16 v20, v36 offset:640
    ds_read_u16 v21, v36 offset:800
    ds_read_u16 v22, v36 offset:960
    ds_read_u16 v23, v36 offset:1120
    ds_read_u16 v24, v36 offset:2048
    ds_read_u16 v25, v36 offset:2208
    ds_read_u16 v26, v36 offset:2368
    ds_read_u16 v27, v36 offset:2528
    ds_read_u16 v28, v36 offset:2688
    ds_read_u16 v29, v36 offset:2848
    ds_read_u16 v30, v36 offset:3008
    ds_read_u16 v31, v36 offset:3168
    s_waitcnt lgkmcnt(8)
    ds_read_u16 v32, v38 offset:64
    ds_read_u16 v33, v38 offset:2112
    v_lshl_or_b32 v44, v17, 16, v16
    v_lshl_or_b32 v45, v19, 16, v18
    v_lshl_or_b32 v46, v21, 16, v20
    v_lshl_or_b32 v47, v23, 16, v22
    buffer_store_dwordx4 v[44:47], v37, s[32:35], s51 offen
    s_waitcnt lgkmcnt(2)
    ds_read_u16 v88, v41 offset:4096
    ds_read_u16 v89, v41 offset:4160
    ds_read_u16 v90, v41 offset:4224
    ds_read_u16 v91, v41 offset:4288
    ds_read_u16 v92, v41 offset:4608
    ds_read_u16 v93, v41 offset:4672
    ds_read_u16 v94, v41 offset:4736
    ds_read_u16 v95, v41 offset:4800
    v_lshl_or_b32 v48, v25, 16, v24
    v_lshl_or_b32 v49, v27, 16, v26
    v_lshl_or_b32 v50, v29, 16, v28
    v_lshl_or_b32 v51, v31, 16, v30
    buffer_store_dwordx4 v[48:51], v37, s[32:35], s51 offen offset:1024
    s_waitcnt lgkmcnt(8)
    buffer_store_short v32, v39, s[32:35], s59 offen
    buffer_store_short v33, v39, s[32:35], s59 offen offset:1024
    s_waitcnt lgkmcnt(0)
    v_lshl_or_b32 v16, v89, 16, v88
    v_lshl_or_b32 v17, v91, 16, v90
    v_lshl_or_b32 v18, v93, 16, v92
    v_lshl_or_b32 v19, v95, 16, v94
    buffer_store_dwordx4 v[16:19], v2, s[32:35], s6 offen
    s_endpgm
k1_compute:
    s_mov_b32 s20, 0x3fb8aa3b
    s_mov_b32 s21, 0x3fb8aa3b
    s_mov_b32 s22, 0x358637bd
    s_mov_b32 s23, 0x358637bd
    s_mov_b32 s24, 0x3f800000
    s_mov_b32 s25, 0x3f800000
    s_mov_b32 s26, 0xffff0000
    s_lshr_b32 s49, s40, 1
    s_and_b32 s50, s40, 1
    v_bfe_u32 v2, v1, 2, 2
    v_lshrrev_b32 v3, 5, v1
    v_lshl_add_u32 v4, v3, 3, v2
    v_lshlrev_b32 v4, 8, v4
    v_bfe_u32 v5, v1, 4, 1
    v_lshl_add_u32 v4, v5, 5, v4
    v_and_b32 v5, 3, v1
    v_lshl_add_u32 v4, v5, 3, v4
    s_waitcnt lgkmcnt(0)
    s_cmp_eq_u32 s36, 3
    s_cbranch_scc1 k1_F
    s_cmp_eq_u32 s36, 0
    s_cbranch_scc1 k1_Q
    v_and_b32 v5, 31, v1
    s_lshl_b32 s45, s50, 1
    v_xor_b32 v2, s45, v2
    s_lshl_b32 s45, s49, 13
    v_bfe_u32 v6, v5, 1, 3
    v_xor_b32 v3, v3, v6
    v_lshlrev_b32 v3, 4, v3
    v_lshl_add_u32 v8, v5, 7, v3
    v_add_u32 v8, s45, v8
    v_xor_b32 v9, 32, v8
    v_xor_b32 v10, 64, v8
    v_xor_b32 v11, 96, v8
    v_lshl_add_u32 v12, v2, 6, v4
    v_xor_b32 v13, 64, v12
    s_mov_b32 s32, s14
    s_mov_b32 s33, s15
    s_mov_b32 s34, 16777216
    s_mov_b32 s35, 0x00020000
    s_lshl_b32 s48, s49, 5
    v_xor_b32 v12, s48, v12
    v_xor_b32 v13, s48, v13
    v_mov_b32 v16, 0x3f803f80
    v_mov_b32 v17, 0x3f803f80
    v_mov_b32 v18, 0x3f803f80
    v_mov_b32 v19, 0x3f803f80
    v_lshlrev_b32 v2, 4, v1
    s_lshl_b32 s47, s50, 12
    s_lshl_b32 s48, s49, 11
    s_add_u32 s48, s48, s47
    v_add_u32 v4, s48, v2
    v_xor_b32 v3, 2304, v4
    v_and_b32 v2, 31, v1
    v_add_u32 v6, 15, v2
    v_lshrrev_b32 v6, 5, v6
    v_lshrrev_b32 v5, 5, v1
    v_mul_u32_u24 v5, 34, v5
    v_add_lshl_u32 v2, v2, v5, 4
    v_lshl_add_u32 v2, v6, 30, v2
    v_bfe_u32 v14, v1, 4, 1
    v_subrev_u32 v14, 1, v14
    s_sub_u32 s58, s36, 1
    s_lshl_b32 s58, s58, 2
    s_add_u32 s58, s39, s58
    s_lshl_b32 s58, s58, 2
    s_lshl_b32 s46, s50, 1
    s_add_u32 s58, s58, s46
    s_add_u32 s58, s58, s49
    s_mul_i32 s58, s58, 16
    s_add_u32 s58, s58, s38
    s_mul_i32 s58, s58, 1152
    s_add_u32 s58, s58, 4194304
    s_lshl_b32 s46, s50, 2
    s_add_u32 s46, s46, 0x20000
    v_mov_b32 v5, s46
    v_mov_b32 v6, 1
    s_mov_b64 vcc, 0
    v_mov_b32 v60, 0
    v_mov_b32 v61, 0
    v_mov_b32 v62, 0
    v_mov_b32 v63, 0
    v_mov_b32 v64, 0
    v_mov_b32 v65, 0
    v_mov_b32 v66, 0
    v_mov_b32 v67, 0
    v_mov_b32 v68, 0
    v_mov_b32 v69, 0
    v_mov_b32 v70, 0
    v_mov_b32 v71, 0
    v_mov_b32 v72, 0
    v_mov_b32 v73, 0
    v_mov_b32 v74, 0
    v_mov_b32 v75, 0
    v_mov_b32 v76, 0
    v_mov_b32 v77, 0
    v_mov_b32 v78, 0
    v_mov_b32 v79, 0
    v_mov_b32 v80, 0
    v_mov_b32 v81, 0
    v_mov_b32 v82, 0
    v_mov_b32 v83, 0
    v_mov_b32 v84, 0
    v_mov_b32 v85, 0
    v_mov_b32 v86, 0
    v_mov_b32 v87, 0
    v_mov_b32 v88, 0
    v_mov_b32 v89, 0
    v_mov_b32 v90, 0
    v_mov_b32 v91, 0
    v_mov_b32 v92, 0
    v_mov_b32 v93, 0
    v_mov_b32 v94, 0
    v_mov_b32 v95, 0
    v_mov_b32 v96, 0
    v_mov_b32 v97, 0
    v_mov_b32 v98, 0
    v_mov_b32 v99, 0
    v_mov_b32 v100, 0
    v_mov_b32 v101, 0
    v_mov_b32 v102, 0
    v_mov_b32 v103, 0
    v_mov_b32 v104, 0
    v_mov_b32 v105, 0
    v_mov_b32 v106, 0
    v_mov_b32 v107, 0
    v_mov_b32 v108, 0
    v_mov_b32 v109, 0
    v_mov_b32 v110, 0
    v_mov_b32 v111, 0
    v_mov_b32 v112, 0
    v_mov_b32 v113, 0
    v_mov_b32 v114, 0
    v_mov_b32 v115, 0
    v_mov_b32 v116, 0
    v_mov_b32 v117, 0
    v_mov_b32 v118, 0
    v_mov_b32 v119, 0
    v_mov_b32 v120, 0
    v_mov_b32 v121, 0
    v_mov_b32 v122, 0
    v_mov_b32 v123, 0
    s_mov_b32 s45, 0
    ds_write_b32 v5, v60
    s_waitcnt lgkmcnt(0)
    s_barrier
    ds_read_b64_tr_b16 v[28:29], v12 offset:16384
    ds_read_b64_tr_b16 v[30:31], v12 offset:17408
    ds_read_b128 v[20:23], v8 offset:0
    ds_read_b64_tr_b16 v[32:33], v13 offset:16384
    ds_read_b64_tr_b16 v[34:35], v13 offset:17408
    ds_read_b128 v[24:27], v8 offset:4096
k1_loop_KV:
    s_waitcnt lgkmcnt(3)
    v_mfma_f32_32x32x16_bf16 v[60:75], v[20:23], v[28:31], v[60:75]
    ds_read_b64_tr_b16 v[48:49], v12 offset:20480
    ds_read_b64_tr_b16 v[50:51], v12 offset:21504
    ds_read_b128 v[40:43], v9 offset:0
    s_waitcnt lgkmcnt(4)
    v_mfma_f32_32x32x16_bf16 v[76:91], v[20:23], v[32:35], v[76:91]
    ds_read_b64_tr_b16 v[52:53], v13 offset:20480
    ds_read_b64_tr_b16 v[54:55], v13 offset:21504
    ds_read_b128 v[44:47], v9 offset:4096
    s_waitcnt lgkmcnt(6)
    v_mfma_f32_32x32x16_bf16 v[92:107], v[24:27], v[28:31], v[92:107]
    v_add_u32 v8, 0x8000, v8
    v_and_b32 v8, 0x1ffff, v8
    v_add_u32 v9, 0x8000, v9
    v_and_b32 v9, 0x1ffff, v9
    v_mfma_f32_32x32x16_bf16 v[108:123], v[24:27], v[32:35], v[108:123]
    s_waitcnt lgkmcnt(3)
    v_mfma_f32_32x32x16_bf16 v[60:75], v[40:43], v[48:51], v[60:75]
    ds_read_b64_tr_b16 v[28:29], v12 offset:24576
    ds_read_b64_tr_b16 v[30:31], v12 offset:25600
    ds_read_b128 v[20:23], v10 offset:0
    s_waitcnt lgkmcnt(4)
    v_mfma_f32_32x32x16_bf16 v[76:91], v[40:43], v[52:55], v[76:91]
    ds_read_b64_tr_b16 v[32:33], v13 offset:24576
    ds_read_b64_tr_b16 v[34:35], v13 offset:25600
    ds_read_b128 v[24:27], v10 offset:4096
    s_waitcnt lgkmcnt(6)
    v_mfma_f32_32x32x16_bf16 v[92:107], v[44:47], v[48:51], v[92:107]
    v_add_u32 v10, 0x8000, v10
    v_and_b32 v10, 0x1ffff, v10
    s_cmp_eq_u32 s45, 7
    s_cbranch_scc1 k1_skip_KV
    s_barrier
k1_skip_KV:
    v_mfma_f32_32x32x16_bf16 v[108:123], v[44:47], v[52:55], v[108:123]
    s_waitcnt lgkmcnt(3)
    v_mfma_f32_32x32x16_bf16 v[60:75], v[20:23], v[28:31], v[60:75]
    ds_read_b64_tr_b16 v[48:49], v12 offset:28672
    ds_read_b64_tr_b16 v[50:51], v12 offset:29696
    ds_read_b128 v[40:43], v11 offset:0
    s_waitcnt lgkmcnt(4)
    v_mfma_f32_32x32x16_bf16 v[76:91], v[20:23], v[32:35], v[76:91]
    ds_read_b64_tr_b16 v[52:53], v13 offset:28672
    ds_read_b64_tr_b16 v[54:55], v13 offset:29696
    ds_read_b128 v[44:47], v11 offset:4096
    s_waitcnt lgkmcnt(6)
    v_mfma_f32_32x32x16_bf16 v[92:107], v[24:27], v[28:31], v[92:107]
    v_add_u32 v11, 0x8000, v11
    v_and_b32 v11, 0x1ffff, v11
    v_add_u32 v12, 0x8000, v12
    v_and_b32 v12, 0x1ffff, v12
    v_add_u32 v13, 0x8000, v13
    v_and_b32 v13, 0x1ffff, v13
    v_mfma_f32_32x32x16_bf16 v[108:123], v[24:27], v[32:35], v[108:123]
    s_waitcnt lgkmcnt(3)
    v_mfma_f32_32x32x16_bf16 v[60:75], v[40:43], v[48:51], v[60:75]
    ds_read_b64_tr_b16 v[28:29], v12 offset:16384
    ds_read_b64_tr_b16 v[30:31], v12 offset:17408
    ds_read_b128 v[20:23], v8 offset:0
    s_waitcnt lgkmcnt(4)
    v_mfma_f32_32x32x16_bf16 v[76:91], v[40:43], v[52:55], v[76:91]
    ds_read_b64_tr_b16 v[32:33], v13 offset:16384
    ds_read_b64_tr_b16 v[34:35], v13 offset:17408
    ds_read_b128 v[24:27], v8 offset:4096
    s_waitcnt lgkmcnt(6)
    v_mfma_f32_32x32x16_bf16 v[92:107], v[44:47], v[48:51], v[92:107]
    v_mfma_f32_32x32x16_bf16 v[108:123], v[44:47], v[52:55], v[108:123]
    s_add_u32 s45, s45, 1
    s_cmp_lt_u32 s45, 8
    s_cbranch_scc1 k1_loop_KV
k1_epi_KV:
    s_waitcnt lgkmcnt(0)
    s_nop 1
    v_cvt_pk_bf16_f32 v140, v76, v77
    v_cvt_pk_bf16_f32 v141, v78, v79
    v_cvt_pk_bf16_f32 v142, v80, v81
    v_cvt_pk_bf16_f32 v143, v82, v83
    v_cvt_pk_bf16_f32 v144, v84, v85
    v_cvt_pk_bf16_f32 v145, v86, v87
    v_cvt_pk_bf16_f32 v146, v88, v89
    v_cvt_pk_bf16_f32 v147, v90, v91
    v_cvt_pk_bf16_f32 v148, v108, v109
    v_cvt_pk_bf16_f32 v149, v110, v111
    v_cvt_pk_bf16_f32 v150, v112, v113
    v_cvt_pk_bf16_f32 v151, v114, v115
    v_cvt_pk_bf16_f32 v152, v116, v117
    v_cvt_pk_bf16_f32 v153, v118, v119
    v_cvt_pk_bf16_f32 v154, v120, v121
    v_cvt_pk_bf16_f32 v155, v122, v123
    v_cvt_pk_bf16_f32 v192, v60, v61
    v_cvt_pk_bf16_f32 v198, v62, v63
    v_cvt_pk_bf16_f32 v204, v64, v65
    v_cvt_pk_bf16_f32 v210, v66, v67
    v_lshlrev_b32 v188, 16, v192
    v_and_b32 v189, s26, v192
    v_lshlrev_b32 v194, 16, v198
    v_and_b32 v195, s26, v198
    v_lshlrev_b32 v200, 16, v204
    v_and_b32 v201, s26, v204
    v_lshlrev_b32 v206, 16, v210
    v_and_b32 v207, s26, v210
    v_pk_mul_f32 v[190:191], v[188:189], s[20:21]
    v_pk_mul_f32 v[196:197], v[194:195], s[20:21]
    v_pk_mul_f32 v[202:203], v[200:201], s[20:21]
    v_pk_mul_f32 v[208:209], v[206:207], s[20:21]
    v_exp_f32 v190, v190 clamp
    v_exp_f32 v191, v191 clamp
    v_exp_f32 v196, v196 clamp
    v_exp_f32 v197, v197 clamp
    v_exp_f32 v202, v202 clamp
    v_exp_f32 v203, v203 clamp
    v_exp_f32 v208, v208 clamp
    v_exp_f32 v209, v209 clamp
    v_pk_add_f32 v[188:189], v[188:189], s[24:25]
    v_pk_add_f32 v[194:195], v[194:195], s[24:25]
    v_pk_add_f32 v[200:201], v[200:201], s[24:25]
    v_pk_add_f32 v[206:207], v[206:207], s[24:25]
    v_pk_add_f32 v[190:191], v[190:191], s[22:23]
    v_pk_add_f32 v[196:197], v[196:197], s[22:23]
    v_pk_add_f32 v[202:203], v[202:203], s[22:23]
    v_pk_add_f32 v[208:209], v[208:209], s[22:23]
    v_max_f32 v188, v188, v190
    v_max_f32 v189, v189, v191
    v_max_f32 v194, v194, v196
    v_max_f32 v195, v195, v197
    v_max_f32 v200, v200, v202
    v_max_f32 v201, v201, v203
    v_max_f32 v206, v206, v208
    v_max_f32 v207, v207, v209
    v_cvt_pk_bf16_f32 v124, v188, v189
    v_cvt_pk_bf16_f32 v125, v194, v195
    v_cvt_pk_bf16_f32 v126, v200, v201
    v_cvt_pk_bf16_f32 v127, v206, v207
    s_nop 1
    v_mfma_f32_32x32x16_bf16 v[156:171], v[124:127], v[140:143], 0
    v_mfma_f32_32x32x16_bf16 v[172:187], v[124:127], v[16:19], 0
    v_cvt_pk_bf16_f32 v192, v68, v69
    v_cvt_pk_bf16_f32 v198, v70, v71
    v_cvt_pk_bf16_f32 v204, v72, v73
    v_cvt_pk_bf16_f32 v210, v74, v75
    v_lshlrev_b32 v188, 16, v192
    v_and_b32 v189, s26, v192
    v_lshlrev_b32 v194, 16, v198
    v_and_b32 v195, s26, v198
    v_lshlrev_b32 v200, 16, v204
    v_and_b32 v201, s26, v204
    v_lshlrev_b32 v206, 16, v210
    v_and_b32 v207, s26, v210
    v_pk_mul_f32 v[190:191], v[188:189], s[20:21]
    v_pk_mul_f32 v[196:197], v[194:195], s[20:21]
    v_pk_mul_f32 v[202:203], v[200:201], s[20:21]
    v_pk_mul_f32 v[208:209], v[206:207], s[20:21]
    v_exp_f32 v190, v190 clamp
    v_exp_f32 v191, v191 clamp
    v_exp_f32 v196, v196 clamp
    v_exp_f32 v197, v197 clamp
    v_exp_f32 v202, v202 clamp
    v_exp_f32 v203, v203 clamp
    v_exp_f32 v208, v208 clamp
    v_exp_f32 v209, v209 clamp
    v_pk_add_f32 v[188:189], v[188:189], s[24:25]
    v_pk_add_f32 v[194:195], v[194:195], s[24:25]
    v_pk_add_f32 v[200:201], v[200:201], s[24:25]
    v_pk_add_f32 v[206:207], v[206:207], s[24:25]
    v_pk_add_f32 v[190:191], v[190:191], s[22:23]
    v_pk_add_f32 v[196:197], v[196:197], s[22:23]
    v_pk_add_f32 v[202:203], v[202:203], s[22:23]
    v_pk_add_f32 v[208:209], v[208:209], s[22:23]
    v_max_f32 v188, v188, v190
    v_max_f32 v189, v189, v191
    v_max_f32 v194, v194, v196
    v_max_f32 v195, v195, v197
    v_max_f32 v200, v200, v202
    v_max_f32 v201, v201, v203
    v_max_f32 v206, v206, v208
    v_max_f32 v207, v207, v209
    v_cvt_pk_bf16_f32 v128, v188, v189
    v_cvt_pk_bf16_f32 v129, v194, v195
    v_cvt_pk_bf16_f32 v130, v200, v201
    v_cvt_pk_bf16_f32 v131, v206, v207
    s_nop 1
    v_mfma_f32_32x32x16_bf16 v[156:171], v[128:131], v[144:147], v[156:171]
    v_mfma_f32_32x32x16_bf16 v[172:187], v[128:131], v[16:19], v[172:187]
    v_cvt_pk_bf16_f32 v192, v92, v93
    v_cvt_pk_bf16_f32 v198, v94, v95
    v_cvt_pk_bf16_f32 v204, v96, v97
    v_cvt_pk_bf16_f32 v210, v98, v99
    v_lshlrev_b32 v188, 16, v192
    v_and_b32 v189, s26, v192
    v_lshlrev_b32 v194, 16, v198
    v_and_b32 v195, s26, v198
    v_lshlrev_b32 v200, 16, v204
    v_and_b32 v201, s26, v204
    v_lshlrev_b32 v206, 16, v210
    v_and_b32 v207, s26, v210
    v_pk_mul_f32 v[190:191], v[188:189], s[20:21]
    v_pk_mul_f32 v[196:197], v[194:195], s[20:21]
    v_pk_mul_f32 v[202:203], v[200:201], s[20:21]
    v_pk_mul_f32 v[208:209], v[206:207], s[20:21]
    v_exp_f32 v190, v190 clamp
    v_exp_f32 v191, v191 clamp
    v_exp_f32 v196, v196 clamp
    v_exp_f32 v197, v197 clamp
    v_exp_f32 v202, v202 clamp
    v_exp_f32 v203, v203 clamp
    v_exp_f32 v208, v208 clamp
    v_exp_f32 v209, v209 clamp
    v_pk_add_f32 v[188:189], v[188:189], s[24:25]
    v_pk_add_f32 v[194:195], v[194:195], s[24:25]
    v_pk_add_f32 v[200:201], v[200:201], s[24:25]
    v_pk_add_f32 v[206:207], v[206:207], s[24:25]
    v_pk_add_f32 v[190:191], v[190:191], s[22:23]
    v_pk_add_f32 v[196:197], v[196:197], s[22:23]
    v_pk_add_f32 v[202:203], v[202:203], s[22:23]
    v_pk_add_f32 v[208:209], v[208:209], s[22:23]
    v_max_f32 v188, v188, v190
    v_max_f32 v189, v189, v191
    v_max_f32 v194, v194, v196
    v_max_f32 v195, v195, v197
    v_max_f32 v200, v200, v202
    v_max_f32 v201, v201, v203
    v_max_f32 v206, v206, v208
    v_max_f32 v207, v207, v209
    v_cvt_pk_bf16_f32 v132, v188, v189
    v_cvt_pk_bf16_f32 v133, v194, v195
    v_cvt_pk_bf16_f32 v134, v200, v201
    v_cvt_pk_bf16_f32 v135, v206, v207
    s_nop 1
    v_mfma_f32_32x32x16_bf16 v[156:171], v[132:135], v[148:151], v[156:171]
    v_mfma_f32_32x32x16_bf16 v[172:187], v[132:135], v[16:19], v[172:187]
    v_cvt_pk_bf16_f32 v192, v100, v101
    v_cvt_pk_bf16_f32 v198, v102, v103
    v_cvt_pk_bf16_f32 v204, v104, v105
    v_cvt_pk_bf16_f32 v210, v106, v107
    v_lshlrev_b32 v188, 16, v192
    v_and_b32 v189, s26, v192
    v_lshlrev_b32 v194, 16, v198
    v_and_b32 v195, s26, v198
    v_lshlrev_b32 v200, 16, v204
    v_and_b32 v201, s26, v204
    v_lshlrev_b32 v206, 16, v210
    v_and_b32 v207, s26, v210
    v_pk_mul_f32 v[190:191], v[188:189], s[20:21]
    v_pk_mul_f32 v[196:197], v[194:195], s[20:21]
    v_pk_mul_f32 v[202:203], v[200:201], s[20:21]
    v_pk_mul_f32 v[208:209], v[206:207], s[20:21]
    v_exp_f32 v190, v190 clamp
    v_exp_f32 v191, v191 clamp
    v_exp_f32 v196, v196 clamp
    v_exp_f32 v197, v197 clamp
    v_exp_f32 v202, v202 clamp
    v_exp_f32 v203, v203 clamp
    v_exp_f32 v208, v208 clamp
    v_exp_f32 v209, v209 clamp
    v_pk_add_f32 v[188:189], v[188:189], s[24:25]
    v_pk_add_f32 v[194:195], v[194:195], s[24:25]
    v_pk_add_f32 v[200:201], v[200:201], s[24:25]
    v_pk_add_f32 v[206:207], v[206:207], s[24:25]
    v_pk_add_f32 v[190:191], v[190:191], s[22:23]
    v_pk_add_f32 v[196:197], v[196:197], s[22:23]
    v_pk_add_f32 v[202:203], v[202:203], s[22:23]
    v_pk_add_f32 v[208:209], v[208:209], s[22:23]
    v_max_f32 v188, v188, v190
    v_max_f32 v189, v189, v191
    v_max_f32 v194, v194, v196
    v_max_f32 v195, v195, v197
    v_max_f32 v200, v200, v202
    v_max_f32 v201, v201, v203
    v_max_f32 v206, v206, v208
    v_max_f32 v207, v207, v209
    v_cvt_pk_bf16_f32 v136, v188, v189
    v_cvt_pk_bf16_f32 v137, v194, v195
    v_cvt_pk_bf16_f32 v138, v200, v201
    v_cvt_pk_bf16_f32 v139, v206, v207
    s_nop 1
    v_mfma_f32_32x32x16_bf16 v[156:171], v[136:139], v[152:155], v[156:171]
    v_mfma_f32_32x32x16_bf16 v[172:187], v[136:139], v[16:19], v[172:187]
    s_nop 11
    v_bfi_b32 v68, v14, v180, v164
    v_bfi_b32 v69, v14, v181, v165
    v_bfi_b32 v70, v14, v182, v166
    v_bfi_b32 v71, v14, v183, v167
    v_bfi_b32 v72, v14, v184, v168
    v_bfi_b32 v73, v14, v185, v169
    v_bfi_b32 v74, v14, v186, v170
    v_bfi_b32 v75, v14, v187, v171
    ds_write_b128 v3, v[68:71] offset:0
    ds_write_b128 v3, v[72:75] offset:1024
    v_bfi_b32 v60, v14, v156, v172
    v_bfi_b32 v61, v14, v157, v173
    v_bfi_b32 v62, v14, v158, v174
    v_bfi_b32 v63, v14, v159, v175
    v_bfi_b32 v64, v14, v160, v176
    v_bfi_b32 v65, v14, v161, v177
    v_bfi_b32 v66, v14, v162, v178
    v_bfi_b32 v67, v14, v163, v179
    s_waitcnt lgkmcnt(0)
    ds_add_u32 v5, v6
k1_kv_poll:
    ds_read_b32 v6, v5
    s_waitcnt lgkmcnt(0)
    v_readfirstlane_b32 s46, v6
    s_nop 0
    s_cmp_lt_u32 s46, 128
    s_cbranch_scc1 k1_kv_poll
    ds_read_b128 v[124:127], v4 offset:0
    ds_read_b128 v[128:131], v4 offset:1024
    s_waitcnt lgkmcnt(1)
    v_pk_add_f32 v[124:125], v[124:125], v[60:61]
    v_pk_add_f32 v[126:127], v[126:127], v[62:63]
    buffer_store_dwordx4 v[124:127], v2, s[32:35], s58 offen offset:0
    s_waitcnt lgkmcnt(0)
    v_pk_add_f32 v[128:129], v[128:129], v[64:65]
    v_pk_add_f32 v[130:131], v[130:131], v[66:67]
    buffer_store_dwordx4 v[128:131], v2, s[32:35], s58 offen offset:272
    s_endpgm
k1_Q:
    v_and_b32 v5, 31, v1
    s_lshl_b32 s45, s50, 1
    v_xor_b32 v2, s45, v2
    s_lshl_b32 s45, s49, 13
    v_bfe_u32 v6, v5, 1, 3
    v_xor_b32 v3, v3, v6
    v_lshlrev_b32 v3, 4, v3
    v_lshl_add_u32 v8, v5, 7, v3
    v_add_u32 v8, s45, v8
    v_xor_b32 v9, 32, v8
    v_xor_b32 v10, 64, v8
    v_xor_b32 v11, 96, v8
    v_lshl_add_u32 v12, v2, 6, v4
    v_xor_b32 v13, 64, v12
    s_mov_b32 s32, s14
    s_mov_b32 s33, s15
    s_mov_b32 s34, 16777216
    s_mov_b32 s35, 0x00020000
    s_mov_b64 vcc, 0
    v_mov_b32 v60, 0
    v_mov_b32 v61, 0
    v_mov_b32 v62, 0
    v_mov_b32 v63, 0
    v_mov_b32 v64, 0
    v_mov_b32 v65, 0
    v_mov_b32 v66, 0
    v_mov_b32 v67, 0
    v_mov_b32 v68, 0
    v_mov_b32 v69, 0
    v_mov_b32 v70, 0
    v_mov_b32 v71, 0
    v_mov_b32 v72, 0
    v_mov_b32 v73, 0
    v_mov_b32 v74, 0
    v_mov_b32 v75, 0
    v_mov_b32 v76, 0
    v_mov_b32 v77, 0
    v_mov_b32 v78, 0
    v_mov_b32 v79, 0
    v_mov_b32 v80, 0
    v_mov_b32 v81, 0
    v_mov_b32 v82, 0
    v_mov_b32 v83, 0
    v_mov_b32 v84, 0
    v_mov_b32 v85, 0
    v_mov_b32 v86, 0
    v_mov_b32 v87, 0
    v_mov_b32 v88, 0
    v_mov_b32 v89, 0
    v_mov_b32 v90, 0
    v_mov_b32 v91, 0
    v_mov_b32 v92, 0
    v_mov_b32 v93, 0
    v_mov_b32 v94, 0
    v_mov_b32 v95, 0
    v_mov_b32 v96, 0
    v_mov_b32 v97, 0
    v_mov_b32 v98, 0
    v_mov_b32 v99, 0
    v_mov_b32 v100, 0
    v_mov_b32 v101, 0
    v_mov_b32 v102, 0
    v_mov_b32 v103, 0
    v_mov_b32 v104, 0
    v_mov_b32 v105, 0
    v_mov_b32 v106, 0
    v_mov_b32 v107, 0
    v_mov_b32 v108, 0
    v_mov_b32 v109, 0
    v_mov_b32 v110, 0
    v_mov_b32 v111, 0
    v_mov_b32 v112, 0
    v_mov_b32 v113, 0
    v_mov_b32 v114, 0
    v_mov_b32 v115, 0
    v_mov_b32 v116, 0
    v_mov_b32 v117, 0
    v_mov_b32 v118, 0
    v_mov_b32 v119, 0
    v_mov_b32 v120, 0
    v_mov_b32 v121, 0
    v_mov_b32 v122, 0
    v_mov_b32 v123, 0
    s_mov_b32 s45, 0
    s_barrier
    ds_read_b64_tr_b16 v[28:29], v12 offset:16384
    ds_read_b64_tr_b16 v[30:31], v12 offset:17408
    ds_read_b128 v[20:23], v8 offset:0
    ds_read_b64_tr_b16 v[32:33], v13 offset:16384
    ds_read_b64_tr_b16 v[34:35], v13 offset:17408
    ds_read_b128 v[24:27], v8 offset:4096
k1_loop_Q:
    s_waitcnt lgkmcnt(3)
    v_mfma_f32_32x32x16_bf16 v[60:75], v[28:31], v[20:23], v[60:75]
    ds_read_b64_tr_b16 v[48:49], v12 offset:20480
    ds_read_b64_tr_b16 v[50:51], v12 offset:21504
    ds_read_b128 v[40:43], v9 offset:0
    s_waitcnt lgkmcnt(4)
    v_mfma_f32_32x32x16_bf16 v[76:91], v[32:35], v[20:23], v[76:91]
    ds_read_b64_tr_b16 v[52:53], v13 offset:20480
    ds_read_b64_tr_b16 v[54:55], v13 offset:21504
    ds_read_b128 v[44:47], v9 offset:4096
    s_waitcnt lgkmcnt(6)
    v_mfma_f32_32x32x16_bf16 v[92:107], v[28:31], v[24:27], v[92:107]
    v_add_u32 v8, 0x8000, v8
    v_and_b32 v8, 0x1ffff, v8
    v_add_u32 v9, 0x8000, v9
    v_and_b32 v9, 0x1ffff, v9
    v_mfma_f32_32x32x16_bf16 v[108:123], v[32:35], v[24:27], v[108:123]
    s_waitcnt lgkmcnt(3)
    v_mfma_f32_32x32x16_bf16 v[60:75], v[48:51], v[40:43], v[60:75]
    ds_read_b64_tr_b16 v[28:29], v12 offset:24576
    ds_read_b64_tr_b16 v[30:31], v12 offset:25600
    ds_read_b128 v[20:23], v10 offset:0
    s_waitcnt lgkmcnt(4)
    v_mfma_f32_32x32x16_bf16 v[76:91], v[52:55], v[40:43], v[76:91]
    ds_read_b64_tr_b16 v[32:33], v13 offset:24576
    ds_read_b64_tr_b16 v[34:35], v13 offset:25600
    ds_read_b128 v[24:27], v10 offset:4096
    s_waitcnt lgkmcnt(6)
    v_mfma_f32_32x32x16_bf16 v[92:107], v[48:51], v[44:47], v[92:107]
    v_add_u32 v10, 0x8000, v10
    v_and_b32 v10, 0x1ffff, v10
    s_cmp_eq_u32 s45, 7
    s_cbranch_scc1 k1_skip_Q
    s_barrier
k1_skip_Q:
    v_mfma_f32_32x32x16_bf16 v[108:123], v[52:55], v[44:47], v[108:123]
    s_waitcnt lgkmcnt(3)
    v_mfma_f32_32x32x16_bf16 v[60:75], v[28:31], v[20:23], v[60:75]
    ds_read_b64_tr_b16 v[48:49], v12 offset:28672
    ds_read_b64_tr_b16 v[50:51], v12 offset:29696
    ds_read_b128 v[40:43], v11 offset:0
    s_waitcnt lgkmcnt(4)
    v_mfma_f32_32x32x16_bf16 v[76:91], v[32:35], v[20:23], v[76:91]
    ds_read_b64_tr_b16 v[52:53], v13 offset:28672
    ds_read_b64_tr_b16 v[54:55], v13 offset:29696
    ds_read_b128 v[44:47], v11 offset:4096
    s_waitcnt lgkmcnt(6)
    v_mfma_f32_32x32x16_bf16 v[92:107], v[28:31], v[24:27], v[92:107]
    v_add_u32 v11, 0x8000, v11
    v_and_b32 v11, 0x1ffff, v11
    v_add_u32 v12, 0x8000, v12
    v_and_b32 v12, 0x1ffff, v12
    v_add_u32 v13, 0x8000, v13
    v_and_b32 v13, 0x1ffff, v13
    v_mfma_f32_32x32x16_bf16 v[108:123], v[32:35], v[24:27], v[108:123]
    s_waitcnt lgkmcnt(3)
    v_mfma_f32_32x32x16_bf16 v[60:75], v[48:51], v[40:43], v[60:75]
    ds_read_b64_tr_b16 v[28:29], v12 offset:16384
    ds_read_b64_tr_b16 v[30:31], v12 offset:17408
    ds_read_b128 v[20:23], v8 offset:0
    s_waitcnt lgkmcnt(4)
    v_mfma_f32_32x32x16_bf16 v[76:91], v[52:55], v[40:43], v[76:91]
    ds_read_b64_tr_b16 v[32:33], v13 offset:16384
    ds_read_b64_tr_b16 v[34:35], v13 offset:17408
    ds_read_b128 v[24:27], v8 offset:4096
    s_waitcnt lgkmcnt(6)
    v_mfma_f32_32x32x16_bf16 v[92:107], v[48:51], v[44:47], v[92:107]
    v_mfma_f32_32x32x16_bf16 v[108:123], v[52:55], v[44:47], v[108:123]
    s_add_u32 s45, s45, 1
    s_cmp_lt_u32 s45, 8
    s_cbranch_scc1 k1_loop_Q
k1_epi_Q:
    s_waitcnt lgkmcnt(0)
    v_lshlrev_b32 v2, 4, v1
    s_lshl_b32 s45, s38, 7
    s_lshl_b32 s46, s49, 6
    s_add_u32 s45, s45, s46
    s_lshl_b32 s46, s39, 3
    s_add_u32 s45, s45, s46
    s_lshl_b32 s46, s50, 2
    s_add_u32 s45, s45, s46
    s_lshl_b32 s45, s45, 10
    s_add_u32 s45, s45, 2097152
    s_add_u32 s46, s45, 32768
    v_cvt_pk_bf16_f32 v192, v60, v61
    v_cvt_pk_bf16_f32 v198, v62, v63
    v_cvt_pk_bf16_f32 v204, v64, v65
    v_cvt_pk_bf16_f32 v210, v66, v67
    v_lshlrev_b32 v188, 16, v192
    v_and_b32 v189, s26, v192
    v_lshlrev_b32 v194, 16, v198
    v_and_b32 v195, s26, v198
    v_lshlrev_b32 v200, 16, v204
    v_and_b32 v201, s26, v204
    v_lshlrev_b32 v206, 16, v210
    v_and_b32 v207, s26, v210
    v_pk_mul_f32 v[190:191], v[188:189], s[20:21]
    v_pk_mul_f32 v[196:197], v[194:195], s[20:21]
    v_pk_mul_f32 v[202:203], v[200:201], s[20:21]
    v_pk_mul_f32 v[208:209], v[206:207], s[20:21]
    v_exp_f32 v190, v190 clamp
    v_exp_f32 v191, v191 clamp
    v_exp_f32 v196, v196 clamp
    v_exp_f32 v197, v197 clamp
    v_exp_f32 v202, v202 clamp
    v_exp_f32 v203, v203 clamp
    v_exp_f32 v208, v208 clamp
    v_exp_f32 v209, v209 clamp
    v_pk_add_f32 v[188:189], v[188:189], s[24:25]
    v_pk_add_f32 v[194:195], v[194:195], s[24:25]
    v_pk_add_f32 v[200:201], v[200:201], s[24:25]
    v_pk_add_f32 v[206:207], v[206:207], s[24:25]
    v_pk_add_f32 v[190:191], v[190:191], s[22:23]
    v_pk_add_f32 v[196:197], v[196:197], s[22:23]
    v_pk_add_f32 v[202:203], v[202:203], s[22:23]
    v_pk_add_f32 v[208:209], v[208:209], s[22:23]
    v_max_f32 v188, v188, v190
    v_max_f32 v189, v189, v191
    v_max_f32 v194, v194, v196
    v_max_f32 v195, v195, v197
    v_max_f32 v200, v200, v202
    v_max_f32 v201, v201, v203
    v_max_f32 v206, v206, v208
    v_max_f32 v207, v207, v209
    v_cvt_pk_bf16_f32 v124, v188, v189
    v_cvt_pk_bf16_f32 v125, v194, v195
    v_cvt_pk_bf16_f32 v126, v200, v201
    v_cvt_pk_bf16_f32 v127, v206, v207
    buffer_store_dwordx4 v[124:127], v2, s[32:35], s45 offen offset:0 sc1
    v_cvt_pk_bf16_f32 v192, v68, v69
    v_cvt_pk_bf16_f32 v198, v70, v71
    v_cvt_pk_bf16_f32 v204, v72, v73
    v_cvt_pk_bf16_f32 v210, v74, v75
    v_lshlrev_b32 v188, 16, v192
    v_and_b32 v189, s26, v192
    v_lshlrev_b32 v194, 16, v198
    v_and_b32 v195, s26, v198
    v_lshlrev_b32 v200, 16, v204
    v_and_b32 v201, s26, v204
    v_lshlrev_b32 v206, 16, v210
    v_and_b32 v207, s26, v210
    v_pk_mul_f32 v[190:191], v[188:189], s[20:21]
    v_pk_mul_f32 v[196:197], v[194:195], s[20:21]
    v_pk_mul_f32 v[202:203], v[200:201], s[20:21]
    v_pk_mul_f32 v[208:209], v[206:207], s[20:21]
    v_exp_f32 v190, v190 clamp
    v_exp_f32 v191, v191 clamp
    v_exp_f32 v196, v196 clamp
    v_exp_f32 v197, v197 clamp
    v_exp_f32 v202, v202 clamp
    v_exp_f32 v203, v203 clamp
    v_exp_f32 v208, v208 clamp
    v_exp_f32 v209, v209 clamp
    v_pk_add_f32 v[188:189], v[188:189], s[24:25]
    v_pk_add_f32 v[194:195], v[194:195], s[24:25]
    v_pk_add_f32 v[200:201], v[200:201], s[24:25]
    v_pk_add_f32 v[206:207], v[206:207], s[24:25]
    v_pk_add_f32 v[190:191], v[190:191], s[22:23]
    v_pk_add_f32 v[196:197], v[196:197], s[22:23]
    v_pk_add_f32 v[202:203], v[202:203], s[22:23]
    v_pk_add_f32 v[208:209], v[208:209], s[22:23]
    v_max_f32 v188, v188, v190
    v_max_f32 v189, v189, v191
    v_max_f32 v194, v194, v196
    v_max_f32 v195, v195, v197
    v_max_f32 v200, v200, v202
    v_max_f32 v201, v201, v203
    v_max_f32 v206, v206, v208
    v_max_f32 v207, v207, v209
    v_cvt_pk_bf16_f32 v128, v188, v189
    v_cvt_pk_bf16_f32 v129, v194, v195
    v_cvt_pk_bf16_f32 v130, v200, v201
    v_cvt_pk_bf16_f32 v131, v206, v207
    buffer_store_dwordx4 v[128:131], v2, s[32:35], s45 offen offset:1024 sc1
    v_cvt_pk_bf16_f32 v192, v92, v93
    v_cvt_pk_bf16_f32 v198, v94, v95
    v_cvt_pk_bf16_f32 v204, v96, v97
    v_cvt_pk_bf16_f32 v210, v98, v99
    v_lshlrev_b32 v188, 16, v192
    v_and_b32 v189, s26, v192
    v_lshlrev_b32 v194, 16, v198
    v_and_b32 v195, s26, v198
    v_lshlrev_b32 v200, 16, v204
    v_and_b32 v201, s26, v204
    v_lshlrev_b32 v206, 16, v210
    v_and_b32 v207, s26, v210
    v_pk_mul_f32 v[190:191], v[188:189], s[20:21]
    v_pk_mul_f32 v[196:197], v[194:195], s[20:21]
    v_pk_mul_f32 v[202:203], v[200:201], s[20:21]
    v_pk_mul_f32 v[208:209], v[206:207], s[20:21]
    v_exp_f32 v190, v190 clamp
    v_exp_f32 v191, v191 clamp
    v_exp_f32 v196, v196 clamp
    v_exp_f32 v197, v197 clamp
    v_exp_f32 v202, v202 clamp
    v_exp_f32 v203, v203 clamp
    v_exp_f32 v208, v208 clamp
    v_exp_f32 v209, v209 clamp
    v_pk_add_f32 v[188:189], v[188:189], s[24:25]
    v_pk_add_f32 v[194:195], v[194:195], s[24:25]
    v_pk_add_f32 v[200:201], v[200:201], s[24:25]
    v_pk_add_f32 v[206:207], v[206:207], s[24:25]
    v_pk_add_f32 v[190:191], v[190:191], s[22:23]
    v_pk_add_f32 v[196:197], v[196:197], s[22:23]
    v_pk_add_f32 v[202:203], v[202:203], s[22:23]
    v_pk_add_f32 v[208:209], v[208:209], s[22:23]
    v_max_f32 v188, v188, v190
    v_max_f32 v189, v189, v191
    v_max_f32 v194, v194, v196
    v_max_f32 v195, v195, v197
    v_max_f32 v200, v200, v202
    v_max_f32 v201, v201, v203
    v_max_f32 v206, v206, v208
    v_max_f32 v207, v207, v209
    v_cvt_pk_bf16_f32 v140, v188, v189
    v_cvt_pk_bf16_f32 v141, v194, v195
    v_cvt_pk_bf16_f32 v142, v200, v201
    v_cvt_pk_bf16_f32 v143, v206, v207
    buffer_store_dwordx4 v[140:143], v2, s[32:35], s46 offen offset:0 sc1
    v_cvt_pk_bf16_f32 v192, v100, v101
    v_cvt_pk_bf16_f32 v198, v102, v103
    v_cvt_pk_bf16_f32 v204, v104, v105
    v_cvt_pk_bf16_f32 v210, v106, v107
    v_lshlrev_b32 v188, 16, v192
    v_and_b32 v189, s26, v192
    v_lshlrev_b32 v194, 16, v198
    v_and_b32 v195, s26, v198
    v_lshlrev_b32 v200, 16, v204
    v_and_b32 v201, s26, v204
    v_lshlrev_b32 v206, 16, v210
    v_and_b32 v207, s26, v210
    v_pk_mul_f32 v[190:191], v[188:189], s[20:21]
    v_pk_mul_f32 v[196:197], v[194:195], s[20:21]
    v_pk_mul_f32 v[202:203], v[200:201], s[20:21]
    v_pk_mul_f32 v[208:209], v[206:207], s[20:21]
    v_exp_f32 v190, v190 clamp
    v_exp_f32 v191, v191 clamp
    v_exp_f32 v196, v196 clamp
    v_exp_f32 v197, v197 clamp
    v_exp_f32 v202, v202 clamp
    v_exp_f32 v203, v203 clamp
    v_exp_f32 v208, v208 clamp
    v_exp_f32 v209, v209 clamp
    v_pk_add_f32 v[188:189], v[188:189], s[24:25]
    v_pk_add_f32 v[194:195], v[194:195], s[24:25]
    v_pk_add_f32 v[200:201], v[200:201], s[24:25]
    v_pk_add_f32 v[206:207], v[206:207], s[24:25]
    v_pk_add_f32 v[190:191], v[190:191], s[22:23]
    v_pk_add_f32 v[196:197], v[196:197], s[22:23]
    v_pk_add_f32 v[202:203], v[202:203], s[22:23]
    v_pk_add_f32 v[208:209], v[208:209], s[22:23]
    v_max_f32 v188, v188, v190
    v_max_f32 v189, v189, v191
    v_max_f32 v194, v194, v196
    v_max_f32 v195, v195, v197
    v_max_f32 v200, v200, v202
    v_max_f32 v201, v201, v203
    v_max_f32 v206, v206, v208
    v_max_f32 v207, v207, v209
    v_cvt_pk_bf16_f32 v144, v188, v189
    v_cvt_pk_bf16_f32 v145, v194, v195
    v_cvt_pk_bf16_f32 v146, v200, v201
    v_cvt_pk_bf16_f32 v147, v206, v207
    buffer_store_dwordx4 v[144:147], v2, s[32:35], s46 offen offset:1024 sc1
    v_cvt_pk_bf16_f32 v192, v76, v77
    v_cvt_pk_bf16_f32 v198, v78, v79
    v_cvt_pk_bf16_f32 v204, v80, v81
    v_cvt_pk_bf16_f32 v210, v82, v83
    v_lshlrev_b32 v188, 16, v192
    v_and_b32 v189, s26, v192
    v_lshlrev_b32 v194, 16, v198
    v_and_b32 v195, s26, v198
    v_lshlrev_b32 v200, 16, v204
    v_and_b32 v201, s26, v204
    v_lshlrev_b32 v206, 16, v210
    v_and_b32 v207, s26, v210
    v_pk_mul_f32 v[190:191], v[188:189], s[20:21]
    v_pk_mul_f32 v[196:197], v[194:195], s[20:21]
    v_pk_mul_f32 v[202:203], v[200:201], s[20:21]
    v_pk_mul_f32 v[208:209], v[206:207], s[20:21]
    v_exp_f32 v190, v190 clamp
    v_exp_f32 v191, v191 clamp
    v_exp_f32 v196, v196 clamp
    v_exp_f32 v197, v197 clamp
    v_exp_f32 v202, v202 clamp
    v_exp_f32 v203, v203 clamp
    v_exp_f32 v208, v208 clamp
    v_exp_f32 v209, v209 clamp
    v_pk_add_f32 v[188:189], v[188:189], s[24:25]
    v_pk_add_f32 v[194:195], v[194:195], s[24:25]
    v_pk_add_f32 v[200:201], v[200:201], s[24:25]
    v_pk_add_f32 v[206:207], v[206:207], s[24:25]
    v_pk_add_f32 v[190:191], v[190:191], s[22:23]
    v_pk_add_f32 v[196:197], v[196:197], s[22:23]
    v_pk_add_f32 v[202:203], v[202:203], s[22:23]
    v_pk_add_f32 v[208:209], v[208:209], s[22:23]
    v_max_f32 v188, v188, v190
    v_max_f32 v189, v189, v191
    v_max_f32 v194, v194, v196
    v_max_f32 v195, v195, v197
    v_max_f32 v200, v200, v202
    v_max_f32 v201, v201, v203
    v_max_f32 v206, v206, v208
    v_max_f32 v207, v207, v209
    v_cvt_pk_bf16_f32 v132, v188, v189
    v_cvt_pk_bf16_f32 v133, v194, v195
    v_cvt_pk_bf16_f32 v134, v200, v201
    v_cvt_pk_bf16_f32 v135, v206, v207
    buffer_store_dwordx4 v[132:135], v2, s[32:35], s45 offen offset:2048 sc1
    v_cvt_pk_bf16_f32 v192, v84, v85
    v_cvt_pk_bf16_f32 v198, v86, v87
    v_cvt_pk_bf16_f32 v204, v88, v89
    v_cvt_pk_bf16_f32 v210, v90, v91
    v_lshlrev_b32 v188, 16, v192
    v_and_b32 v189, s26, v192
    v_lshlrev_b32 v194, 16, v198
    v_and_b32 v195, s26, v198
    v_lshlrev_b32 v200, 16, v204
    v_and_b32 v201, s26, v204
    v_lshlrev_b32 v206, 16, v210
    v_and_b32 v207, s26, v210
    v_pk_mul_f32 v[190:191], v[188:189], s[20:21]
    v_pk_mul_f32 v[196:197], v[194:195], s[20:21]
    v_pk_mul_f32 v[202:203], v[200:201], s[20:21]
    v_pk_mul_f32 v[208:209], v[206:207], s[20:21]
    v_exp_f32 v190, v190 clamp
    v_exp_f32 v191, v191 clamp
    v_exp_f32 v196, v196 clamp
    v_exp_f32 v197, v197 clamp
    v_exp_f32 v202, v202 clamp
    v_exp_f32 v203, v203 clamp
    v_exp_f32 v208, v208 clamp
    v_exp_f32 v209, v209 clamp
    v_pk_add_f32 v[188:189], v[188:189], s[24:25]
    v_pk_add_f32 v[194:195], v[194:195], s[24:25]
    v_pk_add_f32 v[200:201], v[200:201], s[24:25]
    v_pk_add_f32 v[206:207], v[206:207], s[24:25]
    v_pk_add_f32 v[190:191], v[190:191], s[22:23]
    v_pk_add_f32 v[196:197], v[196:197], s[22:23]
    v_pk_add_f32 v[202:203], v[202:203], s[22:23]
    v_pk_add_f32 v[208:209], v[208:209], s[22:23]
    v_max_f32 v188, v188, v190
    v_max_f32 v189, v189, v191
    v_max_f32 v194, v194, v196
    v_max_f32 v195, v195, v197
    v_max_f32 v200, v200, v202
    v_max_f32 v201, v201, v203
    v_max_f32 v206, v206, v208
    v_max_f32 v207, v207, v209
    v_cvt_pk_bf16_f32 v136, v188, v189
    v_cvt_pk_bf16_f32 v137, v194, v195
    v_cvt_pk_bf16_f32 v138, v200, v201
    v_cvt_pk_bf16_f32 v139, v206, v207
    buffer_store_dwordx4 v[136:139], v2, s[32:35], s45 offen offset:3072 sc1
    v_cvt_pk_bf16_f32 v192, v108, v109
    v_cvt_pk_bf16_f32 v198, v110, v111
    v_cvt_pk_bf16_f32 v204, v112, v113
    v_cvt_pk_bf16_f32 v210, v114, v115
    v_lshlrev_b32 v188, 16, v192
    v_and_b32 v189, s26, v192
    v_lshlrev_b32 v194, 16, v198
    v_and_b32 v195, s26, v198
    v_lshlrev_b32 v200, 16, v204
    v_and_b32 v201, s26, v204
    v_lshlrev_b32 v206, 16, v210
    v_and_b32 v207, s26, v210
    v_pk_mul_f32 v[190:191], v[188:189], s[20:21]
    v_pk_mul_f32 v[196:197], v[194:195], s[20:21]
    v_pk_mul_f32 v[202:203], v[200:201], s[20:21]
    v_pk_mul_f32 v[208:209], v[206:207], s[20:21]
    v_exp_f32 v190, v190 clamp
    v_exp_f32 v191, v191 clamp
    v_exp_f32 v196, v196 clamp
    v_exp_f32 v197, v197 clamp
    v_exp_f32 v202, v202 clamp
    v_exp_f32 v203, v203 clamp
    v_exp_f32 v208, v208 clamp
    v_exp_f32 v209, v209 clamp
    v_pk_add_f32 v[188:189], v[188:189], s[24:25]
    v_pk_add_f32 v[194:195], v[194:195], s[24:25]
    v_pk_add_f32 v[200:201], v[200:201], s[24:25]
    v_pk_add_f32 v[206:207], v[206:207], s[24:25]
    v_pk_add_f32 v[190:191], v[190:191], s[22:23]
    v_pk_add_f32 v[196:197], v[196:197], s[22:23]
    v_pk_add_f32 v[202:203], v[202:203], s[22:23]
    v_pk_add_f32 v[208:209], v[208:209], s[22:23]
    v_max_f32 v188, v188, v190
    v_max_f32 v189, v189, v191
    v_max_f32 v194, v194, v196
    v_max_f32 v195, v195, v197
    v_max_f32 v200, v200, v202
    v_max_f32 v201, v201, v203
    v_max_f32 v206, v206, v208
    v_max_f32 v207, v207, v209
    v_cvt_pk_bf16_f32 v148, v188, v189
    v_cvt_pk_bf16_f32 v149, v194, v195
    v_cvt_pk_bf16_f32 v150, v200, v201
    v_cvt_pk_bf16_f32 v151, v206, v207
    buffer_store_dwordx4 v[148:151], v2, s[32:35], s46 offen offset:2048 sc1
    v_cvt_pk_bf16_f32 v192, v116, v117
    v_cvt_pk_bf16_f32 v198, v118, v119
    v_cvt_pk_bf16_f32 v204, v120, v121
    v_cvt_pk_bf16_f32 v210, v122, v123
    v_lshlrev_b32 v188, 16, v192
    v_and_b32 v189, s26, v192
    v_lshlrev_b32 v194, 16, v198
    v_and_b32 v195, s26, v198
    v_lshlrev_b32 v200, 16, v204
    v_and_b32 v201, s26, v204
    v_lshlrev_b32 v206, 16, v210
    v_and_b32 v207, s26, v210
    v_pk_mul_f32 v[190:191], v[188:189], s[20:21]
    v_pk_mul_f32 v[196:197], v[194:195], s[20:21]
    v_pk_mul_f32 v[202:203], v[200:201], s[20:21]
    v_pk_mul_f32 v[208:209], v[206:207], s[20:21]
    v_exp_f32 v190, v190 clamp
    v_exp_f32 v191, v191 clamp
    v_exp_f32 v196, v196 clamp
    v_exp_f32 v197, v197 clamp
    v_exp_f32 v202, v202 clamp
    v_exp_f32 v203, v203 clamp
    v_exp_f32 v208, v208 clamp
    v_exp_f32 v209, v209 clamp
    v_pk_add_f32 v[188:189], v[188:189], s[24:25]
    v_pk_add_f32 v[194:195], v[194:195], s[24:25]
    v_pk_add_f32 v[200:201], v[200:201], s[24:25]
    v_pk_add_f32 v[206:207], v[206:207], s[24:25]
    v_pk_add_f32 v[190:191], v[190:191], s[22:23]
    v_pk_add_f32 v[196:197], v[196:197], s[22:23]
    v_pk_add_f32 v[202:203], v[202:203], s[22:23]
    v_pk_add_f32 v[208:209], v[208:209], s[22:23]
    v_max_f32 v188, v188, v190
    v_max_f32 v189, v189, v191
    v_max_f32 v194, v194, v196
    v_max_f32 v195, v195, v197
    v_max_f32 v200, v200, v202
    v_max_f32 v201, v201, v203
    v_max_f32 v206, v206, v208
    v_max_f32 v207, v207, v209
    v_cvt_pk_bf16_f32 v152, v188, v189
    v_cvt_pk_bf16_f32 v153, v194, v195
    v_cvt_pk_bf16_f32 v154, v200, v201
    v_cvt_pk_bf16_f32 v155, v206, v207
    buffer_store_dwordx4 v[152:155], v2, s[32:35], s46 offen offset:3072 sc1
    s_endpgm
k1_F:
    v_bfe_u32 v5, v1, 2, 2
    v_lshlrev_b32 v5, 3, v5
    v_bfe_u32 v6, v1, 4, 1
    v_lshl_add_u32 v5, v6, 2, v5
    v_and_b32 v6, 3, v1
    v_add_u32 v5, v5, v6
    v_xor_b32 v2, s40, v2
    v_bfe_u32 v6, v5, 1, 3
    v_xor_b32 v3, v3, v6
    v_lshlrev_b32 v3, 4, v3
    v_lshl_add_u32 v8, v5, 7, v3
    v_xor_b32 v9, 32, v8
    v_xor_b32 v10, 64, v8
    v_xor_b32 v11, 96, v8
    v_lshl_add_u32 v12, v2, 6, v4
    v_xor_b32 v13, 64, v12
    s_mov_b32 s32, s14
    s_mov_b32 s33, s15
    s_mov_b32 s34, 16777216
    s_mov_b32 s35, 0x00020000
    s_mov_b64 vcc, 0
    v_mov_b32 v60, 0
    v_mov_b32 v61, 0
    v_mov_b32 v62, 0
    v_mov_b32 v63, 0
    v_mov_b32 v64, 0
    v_mov_b32 v65, 0
    v_mov_b32 v66, 0
    v_mov_b32 v67, 0
    v_mov_b32 v68, 0
    v_mov_b32 v69, 0
    v_mov_b32 v70, 0
    v_mov_b32 v71, 0
    v_mov_b32 v72, 0
    v_mov_b32 v73, 0
    v_mov_b32 v74, 0
    v_mov_b32 v75, 0
    v_mov_b32 v76, 0
    v_mov_b32 v77, 0
    v_mov_b32 v78, 0
    v_mov_b32 v79, 0
    v_mov_b32 v80, 0
    v_mov_b32 v81, 0
    v_mov_b32 v82, 0
    v_mov_b32 v83, 0
    v_mov_b32 v84, 0
    v_mov_b32 v85, 0
    v_mov_b32 v86, 0
    v_mov_b32 v87, 0
    v_mov_b32 v88, 0
    v_mov_b32 v89, 0
    v_mov_b32 v90, 0
    v_mov_b32 v91, 0
    v_mov_b32 v92, 0
    v_mov_b32 v93, 0
    v_mov_b32 v94, 0
    v_mov_b32 v95, 0
    v_mov_b32 v96, 0
    v_mov_b32 v97, 0
    v_mov_b32 v98, 0
    v_mov_b32 v99, 0
    v_mov_b32 v100, 0
    v_mov_b32 v101, 0
    v_mov_b32 v102, 0
    v_mov_b32 v103, 0
    v_mov_b32 v104, 0
    v_mov_b32 v105, 0
    v_mov_b32 v106, 0
    v_mov_b32 v107, 0
    v_mov_b32 v108, 0
    v_mov_b32 v109, 0
    v_mov_b32 v110, 0
    v_mov_b32 v111, 0
    v_mov_b32 v112, 0
    v_mov_b32 v113, 0
    v_mov_b32 v114, 0
    v_mov_b32 v115, 0
    v_mov_b32 v116, 0
    v_mov_b32 v117, 0
    v_mov_b32 v118, 0
    v_mov_b32 v119, 0
    v_mov_b32 v120, 0
    v_mov_b32 v121, 0
    v_mov_b32 v122, 0
    v_mov_b32 v123, 0
    s_mov_b32 s45, 0
    s_barrier
    ds_read_b64_tr_b16 v[36:37], v12 offset:16384
    ds_read_b64_tr_b16 v[38:39], v12 offset:17408
    ds_read_b128 v[20:23], v8 offset:0
    ds_read_b128 v[24:27], v8 offset:4096
    ds_read_b128 v[28:31], v8 offset:8192
    ds_read_b128 v[32:35], v8 offset:12288
k1_loop_F:
    s_waitcnt lgkmcnt(3)
    v_mfma_f32_32x32x16_bf16 v[60:75], v[36:39], v[20:23], v[60:75]
    ds_read_b64_tr_b16 v[56:57], v12 offset:20480
    ds_read_b64_tr_b16 v[58:59], v12 offset:21504
    ds_read_b128 v[40:43], v9 offset:0
    ds_read_b128 v[44:47], v9 offset:4096
    s_waitcnt lgkmcnt(6)
    v_mfma_f32_32x32x16_bf16 v[76:91], v[36:39], v[24:27], v[76:91]
    ds_read_b128 v[48:51], v9 offset:8192
    ds_read_b128 v[52:55], v9 offset:12288
    s_waitcnt lgkmcnt(7)
    v_mfma_f32_32x32x16_bf16 v[92:107], v[36:39], v[28:31], v[92:107]
    v_add_u32 v8, 0x8000, v8
    v_and_b32 v8, 0x1ffff, v8
    v_add_u32 v9, 0x8000, v9
    v_and_b32 v9, 0x1ffff, v9
    s_waitcnt lgkmcnt(6)
    v_mfma_f32_32x32x16_bf16 v[108:123], v[36:39], v[32:35], v[108:123]
    s_waitcnt lgkmcnt(3)
    v_mfma_f32_32x32x16_bf16 v[60:75], v[56:59], v[40:43], v[60:75]
    ds_read_b64_tr_b16 v[36:37], v12 offset:24576
    ds_read_b64_tr_b16 v[38:39], v12 offset:25600
    ds_read_b128 v[20:23], v10 offset:0
    ds_read_b128 v[24:27], v10 offset:4096
    s_waitcnt lgkmcnt(6)
    v_mfma_f32_32x32x16_bf16 v[76:91], v[56:59], v[44:47], v[76:91]
    ds_read_b128 v[28:31], v10 offset:8192
    ds_read_b128 v[32:35], v10 offset:12288
    s_waitcnt lgkmcnt(7)
    v_mfma_f32_32x32x16_bf16 v[92:107], v[56:59], v[48:51], v[92:107]
    v_add_u32 v10, 0x8000, v10
    v_and_b32 v10, 0x1ffff, v10
    s_cmp_eq_u32 s45, 7
    s_cbranch_scc1 k1_skip_F
    s_barrier
k1_skip_F:
    s_waitcnt lgkmcnt(6)
    v_mfma_f32_32x32x16_bf16 v[108:123], v[56:59], v[52:55], v[108:123]
    s_waitcnt lgkmcnt(3)
    v_mfma_f32_32x32x16_bf16 v[60:75], v[36:39], v[20:23], v[60:75]
    ds_read_b64_tr_b16 v[56:57], v12 offset:28672
    ds_read_b64_tr_b16 v[58:59], v12 offset:29696
    ds_read_b128 v[40:43], v11 offset:0
    ds_read_b128 v[44:47], v11 offset:4096
    s_waitcnt lgkmcnt(6)
    v_mfma_f32_32x32x16_bf16 v[76:91], v[36:39], v[24:27], v[76:91]
    ds_read_b128 v[48:51], v11 offset:8192
    ds_read_b128 v[52:55], v11 offset:12288
    s_waitcnt lgkmcnt(7)
    v_mfma_f32_32x32x16_bf16 v[92:107], v[36:39], v[28:31], v[92:107]
    v_add_u32 v11, 0x8000, v11
    v_and_b32 v11, 0x1ffff, v11
    v_add_u32 v12, 0x8000, v12
    v_and_b32 v12, 0x1ffff, v12
    s_waitcnt lgkmcnt(6)
    v_mfma_f32_32x32x16_bf16 v[108:123], v[36:39], v[32:35], v[108:123]
    s_waitcnt lgkmcnt(3)
    v_mfma_f32_32x32x16_bf16 v[60:75], v[56:59], v[40:43], v[60:75]
    ds_read_b64_tr_b16 v[36:37], v12 offset:16384
    ds_read_b64_tr_b16 v[38:39], v12 offset:17408
    ds_read_b128 v[20:23], v8 offset:0
    ds_read_b128 v[24:27], v8 offset:4096
    s_waitcnt lgkmcnt(6)
    v_mfma_f32_32x32x16_bf16 v[76:91], v[56:59], v[44:47], v[76:91]
    ds_read_b128 v[28:31], v8 offset:8192
    ds_read_b128 v[32:35], v8 offset:12288
    s_waitcnt lgkmcnt(7)
    v_mfma_f32_32x32x16_bf16 v[92:107], v[56:59], v[48:51], v[92:107]
    s_waitcnt lgkmcnt(6)
    v_mfma_f32_32x32x16_bf16 v[108:123], v[56:59], v[52:55], v[108:123]
    s_add_u32 s45, s45, 1
    s_cmp_lt_u32 s45, 8
    s_cbranch_scc1 k1_loop_F
k1_epi_F:
    s_waitcnt lgkmcnt(0)
    v_and_b32 v2, 31, v1
    v_lshrrev_b32 v3, 5, v1
    v_lshlrev_b32 v3, 14, v3
    v_lshl_add_u32 v2, v2, 4, v3
    s_lshl_b32 s45, s39, 2
    s_add_u32 s45, s45, s40
    s_lshl_b32 s45, s45, 17
    s_lshl_b32 s46, s38, 9
    s_add_u32 s45, s45, s46
    s_add_u32 s46, s45, 0
    v_cvt_pk_bf16_f32 v124, v60, v76
    v_cvt_pk_bf16_f32 v125, v92, v108
    v_cvt_pk_bf16_f32 v126, v61, v77
    v_cvt_pk_bf16_f32 v127, v93, v109
    buffer_store_dwordx4 v[124:127], v2, s[32:35], s46 offen sc1
    s_add_u32 s46, s45, 8192
    v_cvt_pk_bf16_f32 v128, v62, v78
    v_cvt_pk_bf16_f32 v129, v94, v110
    v_cvt_pk_bf16_f32 v130, v63, v79
    v_cvt_pk_bf16_f32 v131, v95, v111
    buffer_store_dwordx4 v[128:131], v2, s[32:35], s46 offen sc1
    s_add_u32 s46, s45, 32768
    v_cvt_pk_bf16_f32 v132, v64, v80
    v_cvt_pk_bf16_f32 v133, v96, v112
    v_cvt_pk_bf16_f32 v134, v65, v81
    v_cvt_pk_bf16_f32 v135, v97, v113
    buffer_store_dwordx4 v[132:135], v2, s[32:35], s46 offen sc1
    s_add_u32 s46, s45, 40960
    v_cvt_pk_bf16_f32 v136, v66, v82
    v_cvt_pk_bf16_f32 v137, v98, v114
    v_cvt_pk_bf16_f32 v138, v67, v83
    v_cvt_pk_bf16_f32 v139, v99, v115
    buffer_store_dwordx4 v[136:139], v2, s[32:35], s46 offen sc1
    s_add_u32 s46, s45, 65536
    v_cvt_pk_bf16_f32 v140, v68, v84
    v_cvt_pk_bf16_f32 v141, v100, v116
    v_cvt_pk_bf16_f32 v142, v69, v85
    v_cvt_pk_bf16_f32 v143, v101, v117
    buffer_store_dwordx4 v[140:143], v2, s[32:35], s46 offen sc1
    s_add_u32 s46, s45, 73728
    v_cvt_pk_bf16_f32 v144, v70, v86
    v_cvt_pk_bf16_f32 v145, v102, v118
    v_cvt_pk_bf16_f32 v146, v71, v87
    v_cvt_pk_bf16_f32 v147, v103, v119
    buffer_store_dwordx4 v[144:147], v2, s[32:35], s46 offen sc1
    s_add_u32 s46, s45, 98304
    v_cvt_pk_bf16_f32 v148, v72, v88
    v_cvt_pk_bf16_f32 v149, v104, v120
    v_cvt_pk_bf16_f32 v150, v73, v89
    v_cvt_pk_bf16_f32 v151, v105, v121
    buffer_store_dwordx4 v[148:151], v2, s[32:35], s46 offen sc1
    s_add_u32 s46, s45, 106496
    v_cvt_pk_bf16_f32 v152, v74, v90
    v_cvt_pk_bf16_f32 v153, v106, v122
    v_cvt_pk_bf16_f32 v154, v75, v91
    v_cvt_pk_bf16_f32 v155, v107, v123
    buffer_store_dwordx4 v[152:155], v2, s[32:35], s46 offen sc1
    s_endpgm
k1_end:
    s_endpgm
.globl k2_kernel
.p2align 8
.type k2_kernel,@function
k2_kernel:
    s_cmp_ge_u32 s2, 449
    s_cbranch_scc1 k2_end
    s_load_dwordx2 s[12:13], s[0:1], 72
    s_load_dwordx2 s[4:5], s[0:1], 0
    s_load_dwordx2 s[8:9], s[0:1], 48
    v_and_b32 v1, 63, v0
    v_lshrrev_b32 v3, 6, v0
    v_lshlrev_b32 v2, 4, v1
    v_readfirstlane_b32 s40, v3
    s_mov_b32 s47, 0x3fb8aa3b
    s_mov_b32 s48, 0x358637bd
    s_cmp_ge_u32 s2, 257
    s_cbranch_scc1 k2_other
    s_and_b32 s49, s2, 7
    s_lshl_b32 s49, s49, 5
    s_bfe_u32 s41, s2, 0x50003
    s_add_u32 s49, s49, s41
    s_and_b32 s41, s2, 256
    s_add_u32 s49, s49, s41
    v_and_b32 v196, 15, v1
    v_lshrrev_b32 v197, 4, v1
    s_lshl_b32 s41, s40, 4
    v_add_u32 v198, s41, v196
    v_cvt_f32_u32 v198, v198
    v_cvt_f32_u32 v199, v197
    v_mul_f32 v200, 0x3c800000, v198
    v_mul_f32 v201, v200, v199
    v_mul_f32 v201, 4.0, v201
    s_setprio 3
    s_lshl_b32 s45, s49, 12
    s_add_u32 s46, s45, 1048576
    s_sub_u32 s41, s49, 1
    s_cmp_lt_u32 s41, 255
    s_cselect_b32 s46, s46, 1073741824
    s_and_b32 s41, s49, 255
    s_lshl_b32 s41, s41, 13
    s_lshl_b32 s42, s40, 11
    s_add_u32 s41, s41, s42
    s_add_u32 m0, s42, 8192
    v_lshlrev_b32 v207, 4, v196
    v_lshl_add_u32 v207, v197, 9, v207
    s_lshl_b32 s43, s49, 13
    s_lshl_b32 s44, s40, 11
    s_add_u32 s43, s43, s44
    s_add_u32 s43, s43, 6291456
    s_waitcnt lgkmcnt(0)
    s_mov_b32 s16, s12
    s_mov_b32 s17, s13
    s_mov_b32 s18, 16777216
    s_mov_b32 s19, 0x00020000
    buffer_load_dwordx4 v2, s[16:19], s41 offen offset:0 lds
    buffer_load_dwordx4 v2, s[16:19], s41 offen offset:1024 lds
    buffer_load_dwordx4 v[132:135], v2, s[16:19], s43 offen offset:0
    buffer_load_dwordx4 v[136:139], v2, s[16:19], s43 offen offset:1024
    s_add_u32 s28, s12, 9437184
    s_addc_u32 s29, s13, 0
    s_mov_b32 s30, 2097152
    s_mov_b32 s31, 0x00020000
    s_setprio 1
    v_fmamk_f32 v164, v200, 0x0, v201
    v_fmamk_f32 v165, v200, 0x3f800000, v201
    v_fmamk_f32 v166, v200, 0x40000000, v201
    v_fmamk_f32 v167, v200, 0x40400000, v201
    v_cos_f32 v168, v164
    v_sin_f32 v172, v164
    v_cos_f32 v169, v165
    v_sin_f32 v173, v165
    v_cos_f32 v170, v166
    v_sin_f32 v174, v166
    v_cos_f32 v171, v167
    v_sin_f32 v175, v167
    v_cvt_pk_bf16_f32 v38, v168, v169
    v_cvt_pk_bf16_f32 v40, v172, v173
    v_cvt_pk_bf16_f32 v39, v170, v171
    v_cvt_pk_bf16_f32 v41, v174, v175
    v_mov_b32 v42, v38
    v_xor_b32 v36, 0x80008000, v40
    v_xor_b32 v44, 0x80008000, v40
    v_mov_b32 v43, v39
    v_xor_b32 v37, 0x80008000, v41
    v_xor_b32 v45, 0x80008000, v41
    v_and_b32 v164, 1, v196
    v_sub_u32 v164, 0, v164
    v_and_b32 v165, 0x80008000, v164
    v_bfe_u32 v166, v196, 1, 1
    v_sub_u32 v166, 0, v166
    v_and_b32 v166, 0x80008000, v166
    v_xor_b32 v167, v165, v166
    v_bfi_b32 v48, v164, v40, v38
    v_bfi_b32 v50, v164, v38, v40
    v_bfi_b32 v49, v164, v41, v39
    v_bfi_b32 v51, v164, v39, v41
    v_xor_b32 v48, v167, v48
    v_xor_b32 v50, v166, v50
    v_xor_b32 v49, v167, v49
    v_xor_b32 v51, v166, v51
    v_xor_b32 v58, v165, v38
    v_xor_b32 v68, v165, v48
    v_xor_b32 v59, v165, v39
    v_xor_b32 v69, v165, v49
    v_xor_b32 v60, v165, v40
    v_xor_b32 v70, v165, v50
    v_xor_b32 v61, v165, v41
    v_xor_b32 v71, v165, v51
    v_mov_b32 v52, v48
    v_xor_b32 v46, 0x80008000, v50
    v_xor_b32 v54, 0x80008000, v50
    v_mov_b32 v53, v49
    v_xor_b32 v47, 0x80008000, v51
    v_xor_b32 v55, 0x80008000, v51
    v_mov_b32 v62, v58
    v_xor_b32 v56, 0x80008000, v60
    v_xor_b32 v64, 0x80008000, v60
    v_mov_b32 v63, v59
    v_xor_b32 v57, 0x80008000, v61
    v_xor_b32 v65, 0x80008000, v61
    v_mov_b32 v72, v68
    v_xor_b32 v66, 0x80008000, v70
    v_xor_b32 v74, 0x80008000, v70
    v_mov_b32 v73, v69
    v_xor_b32 v67, 0x80008000, v71
    v_xor_b32 v75, 0x80008000, v71
    v_mul_f32 v200, 0x3a000000, v198
    v_mul_f32 v201, v200, v199
    v_mul_f32 v201, 0x41000000, v201
    v_fmamk_f32 v164, v200, 0x0, v201
    v_fmamk_f32 v165, v200, 0x3f800000, v201
    v_fmamk_f32 v166, v200, 0x40000000, v201
    v_fmamk_f32 v167, v200, 0x40400000, v201
    v_fmamk_f32 v168, v200, 0x40800000, v201
    v_fmamk_f32 v169, v200, 0x40a00000, v201
    v_fmamk_f32 v170, v200, 0x40c00000, v201
    v_fmamk_f32 v171, v200, 0x40e00000, v201
    v_cos_f32 v100, v164
    v_sin_f32 v108, -v164
    v_cos_f32 v101, v165
    v_sin_f32 v109, -v165
    v_cos_f32 v102, v166
    v_sin_f32 v110, -v166
    v_cos_f32 v103, v167
    v_sin_f32 v111, -v167
    v_cos_f32 v104, v168
    v_sin_f32 v112, -v168
    v_cos_f32 v105, v169
    v_sin_f32 v113, -v169
    v_cos_f32 v106, v170
    v_sin_f32 v114, -v170
    v_cos_f32 v107, v171
    v_sin_f32 v115, -v171
    v_lshrrev_b32 v202, 2, v196
    v_and_b32 v203, 3, v196
    v_lshl_add_u32 v202, v202, 3, v203
    v_cvt_f32_u32 v202, v202
    v_add_f32 v203, 4.0, v202
    v_mul_f32 v200, 0x3d000000, v202
    v_mul_f32 v201, v200, v199
    v_mul_f32 v201, 0x41000000, v201
    v_fmamk_f32 v164, v200, 0x0, v201
    v_fmamk_f32 v165, v200, 0x3f800000, v201
    v_fmamk_f32 v166, v200, 0x40000000, v201
    v_fmamk_f32 v167, v200, 0x40400000, v201
    v_cos_f32 v168, v164
    v_sin_f32 v172, v164
    v_cos_f32 v169, v165
    v_sin_f32 v173, v165
    v_cos_f32 v170, v166
    v_sin_f32 v174, v166
    v_cos_f32 v171, v167
    v_sin_f32 v175, v167
    v_cvt_pk_bf16_f32 v76, v168, v169
    v_cvt_pk_bf16_f32 v80, v172, v173
    v_cvt_pk_bf16_f32 v77, v170, v171
    v_cvt_pk_bf16_f32 v81, v174, v175
    v_xor_b32 v84, 0x80008000, v80
    v_xor_b32 v85, 0x80008000, v81
    v_fmamk_f32 v164, v200, 0x40800000, v201
    v_fmamk_f32 v165, v200, 0x40a00000, v201
    v_fmamk_f32 v166, v200, 0x40c00000, v201
    v_fmamk_f32 v167, v200, 0x40e00000, v201
    v_cos_f32 v168, v164
    v_sin_f32 v172, v164
    v_cos_f32 v169, v165
    v_sin_f32 v173, v165
    v_cos_f32 v170, v166
    v_sin_f32 v174, v166
    v_cos_f32 v171, v167
    v_sin_f32 v175, v167
    v_cvt_pk_bf16_f32 v78, v168, v169
    v_cvt_pk_bf16_f32 v82, v172, v173
    v_cvt_pk_bf16_f32 v79, v170, v171
    v_cvt_pk_bf16_f32 v83, v174, v175
    v_xor_b32 v86, 0x80008000, v82
    v_xor_b32 v87, 0x80008000, v83
    v_mul_f32 v200, 0x3d000000, v203
    v_mul_f32 v201, v200, v199
    v_mul_f32 v201, 0x41000000, v201
    v_fmamk_f32 v164, v200, 0x0, v201
    v_fmamk_f32 v165, v200, 0x3f800000, v201
    v_fmamk_f32 v166, v200, 0x40000000, v201
    v_fmamk_f32 v167, v200, 0x40400000, v201
    v_cos_f32 v168, v164
    v_sin_f32 v172, v164
    v_cos_f32 v169, v165
    v_sin_f32 v173, v165
    v_cos_f32 v170, v166
    v_sin_f32 v174, v166
    v_cos_f32 v171, v167
    v_sin_f32 v175, v167
    v_cvt_pk_bf16_f32 v88, v168, v169
    v_cvt_pk_bf16_f32 v92, v172, v173
    v_cvt_pk_bf16_f32 v89, v170, v171
    v_cvt_pk_bf16_f32 v93, v174, v175
    v_xor_b32 v96, 0x80008000, v92
    v_xor_b32 v97, 0x80008000, v93
    v_fmamk_f32 v164, v200, 0x40800000, v201
    v_fmamk_f32 v165, v200, 0x40a00000, v201
    v_fmamk_f32 v166, v200, 0x40c00000, v201
    v_fmamk_f32 v167, v200, 0x40e00000, v201
    v_cos_f32 v168, v164
    v_sin_f32 v172, v164
    v_cos_f32 v169, v165
    v_sin_f32 v173, v165
    v_cos_f32 v170, v166
    v_sin_f32 v174, v166
    v_cos_f32 v171, v167
    v_sin_f32 v175, v167
    v_cvt_pk_bf16_f32 v90, v168, v169
    v_cvt_pk_bf16_f32 v94, v172, v173
    v_cvt_pk_bf16_f32 v91, v170, v171
    v_cvt_pk_bf16_f32 v95, v174, v175
    v_xor_b32 v98, 0x80008000, v94
    v_xor_b32 v99, 0x80008000, v95
    s_lshl_b32 s41, s40, 4
    v_lshl_add_u32 v198, v197, 2, s41
    v_cvt_f32_u32 v198, v198
    v_mul_f32 v200, 0x3a000000, v202
    v_mul_f32 v201, v200, v198
    v_fmamk_f32 v164, v200, 0x0, v201
    v_fmamk_f32 v165, v200, 0x3f800000, v201
    v_fmamk_f32 v166, v200, 0x40000000, v201
    v_fmamk_f32 v167, v200, 0x40400000, v201
    v_cos_f32 v116, v164
    v_sin_f32 v124, v164
    v_cos_f32 v117, v165
    v_sin_f32 v125, v165
    v_cos_f32 v118, v166
    v_sin_f32 v126, v166
    v_cos_f32 v119, v167
    v_sin_f32 v127, v167
    v_mul_f32 v200, 0x3a000000, v203
    v_mul_f32 v201, v200, v198
    v_fmamk_f32 v164, v200, 0x0, v201
    v_fmamk_f32 v165, v200, 0x3f800000, v201
    v_fmamk_f32 v166, v200, 0x40000000, v201
    v_fmamk_f32 v167, v200, 0x40400000, v201
    v_cos_f32 v120, v164
    v_sin_f32 v128, v164
    v_cos_f32 v121, v165
    v_sin_f32 v129, v165
    v_cos_f32 v122, v166
    v_sin_f32 v130, v166
    v_cos_f32 v123, v167
    v_sin_f32 v131, v167
    s_lshl_b32 s41, s40, 10
    v_add_u32 v3, s41, v2
    v_lshlrev_b32 v196, 6, v196
    v_lshl_add_u32 v196, v197, 4, v196
    v_add_u32 v196, s41, v196
    s_setprio 3
    s_waitcnt vmcnt(2)
    s_barrier
    ds_read_b128 v[4:7], v207 offset:8192
    ds_read_b128 v[8:11], v207 offset:8448
    ds_read_b128 v[12:15], v207 offset:10240
    ds_read_b128 v[16:19], v207 offset:10496
    ds_read_b128 v[20:23], v207 offset:12288
    ds_read_b128 v[24:27], v207 offset:12544
    ds_read_b128 v[28:31], v207 offset:14336
    ds_read_b128 v[32:35], v207 offset:14592
    s_waitcnt vmcnt(0)
    v_lshlrev_b32 v203, 6, v0
    s_lshr_b32 s41, s2, 3
    s_lshl_b32 s41, s41, 14
    s_add_u32 s41, s41, 13631488
    buffer_load_dword v206, v203, s[16:19], s41 offen
    s_waitcnt lgkmcnt(0)
    s_cmp_eq_u32 s46, 1073741824
    s_cbranch_scc1 k2_fix
k2_fixed:
    s_nop 1
    v_mfma_f32_16x16x32_bf16 v[140:143], v[4:7], v[38:41], 0
    v_mfma_f32_16x16x32_bf16 v[148:151], v[4:7], v[36:39], 0
    v_mfma_f32_16x16x32_bf16 v[144:147], v[8:11], v[38:41], 0
    v_mfma_f32_16x16x32_bf16 v[152:155], v[8:11], v[36:39], 0
    v_mfma_f32_16x16x32_bf16 v[140:143], v[12:15], v[48:51], v[140:143]
    v_mfma_f32_16x16x32_bf16 v[148:151], v[12:15], v[46:49], v[148:151]
    v_mfma_f32_16x16x32_bf16 v[144:147], v[16:19], v[48:51], v[144:147]
    v_mfma_f32_16x16x32_bf16 v[152:155], v[16:19], v[46:49], v[152:155]
    v_mfma_f32_16x16x32_bf16 v[140:143], v[20:23], v[58:61], v[140:143]
    v_mfma_f32_16x16x32_bf16 v[148:151], v[20:23], v[56:59], v[148:151]
    v_mfma_f32_16x16x32_bf16 v[144:147], v[24:27], v[58:61], v[144:147]
    v_mfma_f32_16x16x32_bf16 v[152:155], v[24:27], v[56:59], v[152:155]
    v_mfma_f32_16x16x32_bf16 v[140:143], v[28:31], v[68:71], v[140:143]
    v_mfma_f32_16x16x32_bf16 v[148:151], v[28:31], v[66:69], v[148:151]
    v_mfma_f32_16x16x32_bf16 v[144:147], v[32:35], v[68:71], v[144:147]
    v_mfma_f32_16x16x32_bf16 v[152:155], v[32:35], v[66:69], v[152:155]
    v_lshlrev_b32 v4, 16, v132
    v_and_b32 v5, 0xffff0000, v132
    v_lshlrev_b32 v6, 16, v133
    v_and_b32 v7, 0xffff0000, v133
    v_lshlrev_b32 v8, 16, v134
    v_and_b32 v9, 0xffff0000, v134
    v_lshlrev_b32 v10, 16, v135
    v_and_b32 v11, 0xffff0000, v135
    v_lshlrev_b32 v12, 16, v136
    v_and_b32 v13, 0xffff0000, v136
    v_lshlrev_b32 v14, 16, v137
    v_and_b32 v15, 0xffff0000, v137
    v_lshlrev_b32 v16, 16, v138
    v_and_b32 v17, 0xffff0000, v138
    v_lshlrev_b32 v18, 16, v139
    v_and_b32 v19, 0xffff0000, v139
    v_pk_mul_f32 v[164:165], v[148:149], v[108:109]
    v_pk_mul_f32 v[166:167], v[150:151], v[110:111]
    v_pk_mul_f32 v[168:169], v[152:153], v[112:113]
    v_pk_mul_f32 v[170:171], v[154:155], v[114:115]
    v_pk_mul_f32 v[172:173], v[148:149], v[100:101]
    v_pk_mul_f32 v[174:175], v[150:151], v[102:103]
    v_pk_mul_f32 v[176:177], v[152:153], v[104:105]
    v_pk_mul_f32 v[178:179], v[154:155], v[106:107]
    v_pk_fma_f32 v[164:165], v[140:141], v[100:101], v[164:165] neg_lo:[0,0,1] neg_hi:[0,0,1]
    v_pk_fma_f32 v[166:167], v[142:143], v[102:103], v[166:167] neg_lo:[0,0,1] neg_hi:[0,0,1]
    v_pk_fma_f32 v[168:169], v[144:145], v[104:105], v[168:169] neg_lo:[0,0,1] neg_hi:[0,0,1]
    v_pk_fma_f32 v[170:171], v[146:147], v[106:107], v[170:171] neg_lo:[0,0,1] neg_hi:[0,0,1]
    v_pk_fma_f32 v[172:173], v[140:141], v[108:109], v[172:173]
    v_pk_fma_f32 v[174:175], v[142:143], v[110:111], v[174:175]
    v_pk_fma_f32 v[176:177], v[144:145], v[112:113], v[176:177]
    v_pk_fma_f32 v[178:179], v[146:147], v[114:115], v[178:179]
    v_cvt_pk_bf16_f32 v156, v164, v165
    v_cvt_pk_bf16_f32 v157, v166, v167
    v_cvt_pk_bf16_f32 v158, v168, v169
    v_cvt_pk_bf16_f32 v159, v170, v171
    v_cvt_pk_bf16_f32 v160, v172, v173
    v_cvt_pk_bf16_f32 v161, v174, v175
    v_cvt_pk_bf16_f32 v162, v176, v177
    v_cvt_pk_bf16_f32 v163, v178, v179
    v_mfma_f32_16x16x32_bf16 v[180:183], v[76:79], v[156:159], 0
    s_nop 0
    v_mfma_f32_16x16x32_bf16 v[188:191], v[76:79], v[160:163], 0
    v_mfma_f32_16x16x32_bf16 v[184:187], v[88:91], v[156:159], 0
    v_mfma_f32_16x16x32_bf16 v[192:195], v[88:91], v[160:163], 0
    v_mfma_f32_16x16x32_bf16 v[180:183], v[80:83], v[160:163], v[180:183]
    v_mfma_f32_16x16x32_bf16 v[188:191], v[84:87], v[156:159], v[188:191]
    v_mfma_f32_16x16x32_bf16 v[184:187], v[92:95], v[160:163], v[184:187]
    v_mfma_f32_16x16x32_bf16 v[192:195], v[96:99], v[156:159], v[192:195]
    s_nop 5
    v_pk_mul_f32 v[164:165], v[188:189], v[12:13]
    v_pk_mul_f32 v[166:167], v[190:191], v[14:15]
    v_pk_mul_f32 v[168:169], v[192:193], v[16:17]
    v_pk_mul_f32 v[170:171], v[194:195], v[18:19]
    v_pk_mul_f32 v[172:173], v[188:189], v[4:5]
    v_pk_mul_f32 v[174:175], v[190:191], v[6:7]
    v_pk_mul_f32 v[176:177], v[192:193], v[8:9]
    v_pk_mul_f32 v[178:179], v[194:195], v[10:11]
    v_pk_fma_f32 v[164:165], v[180:181], v[4:5], v[164:165] neg_lo:[0,0,1] neg_hi:[0,0,1]
    v_pk_fma_f32 v[166:167], v[182:183], v[6:7], v[166:167] neg_lo:[0,0,1] neg_hi:[0,0,1]
    v_pk_fma_f32 v[168:169], v[184:185], v[8:9], v[168:169] neg_lo:[0,0,1] neg_hi:[0,0,1]
    v_pk_fma_f32 v[170:171], v[186:187], v[10:11], v[170:171] neg_lo:[0,0,1] neg_hi:[0,0,1]
    v_pk_fma_f32 v[172:173], v[180:181], v[12:13], v[172:173]
    v_pk_fma_f32 v[174:175], v[182:183], v[14:15], v[174:175]
    v_pk_fma_f32 v[176:177], v[184:185], v[16:17], v[176:177]
    v_pk_fma_f32 v[178:179], v[186:187], v[18:19], v[178:179]
    v_cvt_pk_bf16_f32 v156, v164, v165
    v_cvt_pk_bf16_f32 v157, v166, v167
    v_cvt_pk_bf16_f32 v158, v168, v169
    v_cvt_pk_bf16_f32 v159, v170, v171
    v_cvt_pk_bf16_f32 v160, v172, v173
    v_cvt_pk_bf16_f32 v161, v174, v175
    v_cvt_pk_bf16_f32 v162, v176, v177
    v_cvt_pk_bf16_f32 v163, v178, v179
    v_mfma_f32_16x16x32_bf16 v[140:143], v[156:159], v[76:79], 0
    s_nop 0
    v_mfma_f32_16x16x32_bf16 v[148:151], v[160:163], v[76:79], 0
    v_mfma_f32_16x16x32_bf16 v[144:147], v[156:159], v[88:91], 0
    v_mfma_f32_16x16x32_bf16 v[152:155], v[160:163], v[88:91], 0
    v_mfma_f32_16x16x32_bf16 v[140:143], v[160:163], v[84:87], v[140:143]
    v_mfma_f32_16x16x32_bf16 v[148:151], v[156:159], v[80:83], v[148:151]
    v_mfma_f32_16x16x32_bf16 v[144:147], v[160:163], v[96:99], v[144:147]
    v_mfma_f32_16x16x32_bf16 v[152:155], v[156:159], v[92:95], v[152:155]
    s_nop 5
    v_pk_mul_f32 v[164:165], v[148:149], v[124:125]
    v_pk_mul_f32 v[166:167], v[150:151], v[126:127]
    v_pk_mul_f32 v[168:169], v[152:153], v[128:129]
    v_pk_mul_f32 v[170:171], v[154:155], v[130:131]
    v_pk_mul_f32 v[172:173], v[148:149], v[116:117]
    v_pk_mul_f32 v[174:175], v[150:151], v[118:119]
    v_pk_mul_f32 v[176:177], v[152:153], v[120:121]
    v_pk_mul_f32 v[178:179], v[154:155], v[122:123]
    v_pk_fma_f32 v[164:165], v[140:141], v[116:117], v[164:165] neg_lo:[0,0,1] neg_hi:[0,0,1]
    v_pk_fma_f32 v[166:167], v[142:143], v[118:119], v[166:167] neg_lo:[0,0,1] neg_hi:[0,0,1]
    v_pk_fma_f32 v[168:169], v[144:145], v[120:121], v[168:169] neg_lo:[0,0,1] neg_hi:[0,0,1]
    v_pk_fma_f32 v[170:171], v[146:147], v[122:123], v[170:171] neg_lo:[0,0,1] neg_hi:[0,0,1]
    v_pk_fma_f32 v[172:173], v[140:141], v[124:125], v[172:173]
    v_pk_fma_f32 v[174:175], v[142:143], v[126:127], v[174:175]
    v_pk_fma_f32 v[176:177], v[144:145], v[128:129], v[176:177]
    v_pk_fma_f32 v[178:179], v[146:147], v[130:131], v[178:179]
    v_cvt_pk_bf16_f32 v156, v164, v165
    v_cvt_pk_bf16_f32 v157, v166, v167
    v_cvt_pk_bf16_f32 v160, v168, v169
    v_cvt_pk_bf16_f32 v161, v170, v171
    v_cvt_pk_bf16_f32 v158, v172, v173
    v_cvt_pk_bf16_f32 v159, v174, v175
    v_cvt_pk_bf16_f32 v162, v176, v177
    v_cvt_pk_bf16_f32 v163, v178, v179
    ds_write_b128 v3, v[156:159] offset:0
    ds_write_b128 v3, v[160:163] offset:4096
    s_waitcnt lgkmcnt(0)
    s_barrier
    ds_read_b128 v[4:7], v2 offset:0
    ds_read_b128 v[8:11], v2 offset:1024
    ds_read_b128 v[12:15], v2 offset:2048
    ds_read_b128 v[16:19], v2 offset:3072
    ds_read_b128 v[20:23], v2 offset:4096
    ds_read_b128 v[24:27], v2 offset:5120
    ds_read_b128 v[28:31], v2 offset:6144
    ds_read_b128 v[32:35], v2 offset:7168
    s_waitcnt lgkmcnt(7)
    v_mfma_f32_16x16x32_bf16 v[180:183], v[4:7], v[42:45], 0
    v_mfma_f32_16x16x32_bf16 v[188:191], v[4:7], v[40:43], 0
    s_waitcnt lgkmcnt(6)
    v_mfma_f32_16x16x32_bf16 v[180:183], v[8:11], v[52:55], v[180:183]
    v_mfma_f32_16x16x32_bf16 v[188:191], v[8:11], v[50:53], v[188:191]
    s_waitcnt lgkmcnt(5)
    v_mfma_f32_16x16x32_bf16 v[180:183], v[12:15], v[62:65], v[180:183]
    v_mfma_f32_16x16x32_bf16 v[188:191], v[12:15], v[60:63], v[188:191]
    s_waitcnt lgkmcnt(4)
    v_mfma_f32_16x16x32_bf16 v[180:183], v[16:19], v[72:75], v[180:183]
    v_mfma_f32_16x16x32_bf16 v[188:191], v[16:19], v[70:73], v[188:191]
    s_waitcnt lgkmcnt(3)
    v_mfma_f32_16x16x32_bf16 v[184:187], v[20:23], v[42:45], 0
    v_mfma_f32_16x16x32_bf16 v[192:195], v[20:23], v[40:43], 0
    s_waitcnt lgkmcnt(2)
    v_mfma_f32_16x16x32_bf16 v[184:187], v[24:27], v[52:55], v[184:187]
    v_mfma_f32_16x16x32_bf16 v[192:195], v[24:27], v[50:53], v[192:195]
    s_waitcnt lgkmcnt(1)
    v_mfma_f32_16x16x32_bf16 v[184:187], v[28:31], v[62:65], v[184:187]
    v_mfma_f32_16x16x32_bf16 v[192:195], v[28:31], v[60:63], v[192:195]
    s_waitcnt lgkmcnt(0)
    v_mfma_f32_16x16x32_bf16 v[184:187], v[32:35], v[72:75], v[184:187]
    v_mfma_f32_16x16x32_bf16 v[192:195], v[32:35], v[70:73], v[192:195]
    v_cvt_pk_bf16_f32 v156, v180, v181
    v_cvt_pk_bf16_f32 v157, v182, v183
    s_nop 4
    v_cvt_pk_bf16_f32 v158, v184, v185
    v_cvt_pk_bf16_f32 v159, v186, v187
    v_cvt_pk_bf16_f32 v160, v188, v189
    v_cvt_pk_bf16_f32 v161, v190, v191
    v_cvt_pk_bf16_f32 v162, v192, v193
    v_cvt_pk_bf16_f32 v163, v194, v195
    buffer_store_dwordx4 v[156:159], v196, s[28:31], s45 offen
    buffer_store_dwordx4 v[160:163], v196, s[28:31], s46 offen
    s_endpgm
k2_fix:
    s_cmp_eq_u32 s49, 0
    s_cbranch_scc1 k2_fix0
    v_mov_b32 v4, v6
    v_mov_b32 v5, v7
    v_mov_b32 v8, v10
    v_mov_b32 v9, v11
    v_mov_b32 v12, v14
    v_mov_b32 v13, v15
    v_mov_b32 v16, v18
    v_mov_b32 v17, v19
    v_mov_b32 v20, v22
    v_mov_b32 v21, v23
    v_mov_b32 v24, v26
    v_mov_b32 v25, v27
    v_mov_b32 v28, v30
    v_mov_b32 v29, v31
    v_mov_b32 v32, v34
    v_mov_b32 v33, v35
k2_fix0:
    v_mov_b32 v6, 0
    v_mov_b32 v7, 0
    v_mov_b32 v10, 0
    v_mov_b32 v11, 0
    v_mov_b32 v14, 0
    v_mov_b32 v15, 0
    v_mov_b32 v18, 0
    v_mov_b32 v19, 0
    v_mov_b32 v22, 0
    v_mov_b32 v23, 0
    v_mov_b32 v26, 0
    v_mov_b32 v27, 0
    v_mov_b32 v30, 0
    v_mov_b32 v31, 0
    v_mov_b32 v34, 0
    v_mov_b32 v35, 0
    s_branch k2_fixed
k2_other:
    s_setprio 2
    s_waitcnt lgkmcnt(0)
    s_mov_b32 s16, s12
    s_mov_b32 s17, s13
    s_mov_b32 s18, 16777216
    s_mov_b32 s19, 0x00020000
    s_cmp_ge_u32 s2, 385
    s_cbranch_scc1 k2_gate
    s_sub_u32 s41, s2, 257
    s_and_b32 s42, s41, 31
    s_lshr_b32 s41, s41, 5
    s_mul_i32 s43, s42, 18432
    s_lshl_b32 s44, s40, 10
    s_add_u32 s43, s43, s44
    s_add_u32 s43, s43, 4194304
    s_add_u32 s44, s44, 8192
    s_add_u32 m0, s44, 0
    s_nop 0
    buffer_load_dwordx4 v2, s[16:19], s43 offen lds
    s_add_u32 s43, s43, 4096
    s_add_u32 m0, s44, 4096
    s_nop 0
    buffer_load_dwordx4 v2, s[16:19], s43 offen lds
    s_add_u32 s43, s43, 4096
    s_add_u32 m0, s44, 8192
    s_nop 0
    buffer_load_dwordx4 v2, s[16:19], s43 offen lds
    s_add_u32 s43, s43, 4096
    s_add_u32 m0, s44, 12288
    s_nop 0
    buffer_load_dwordx4 v2, s[16:19], s43 offen lds
    s_add_u32 s43, s43, 4096
    s_add_u32 m0, s44, 16384
    s_cmp_lt_u32 s40, 2
    s_cselect_b32 s43, s43, 1073741824
    buffer_load_dwordx4 v2, s[16:19], s43 offen lds
    v_and_b32 v3, 31, v1
    v_min_u32 v3, 16, v3
    v_lshrrev_b32 v84, 5, v1
    v_mul_u32_u24 v84, 34, v84
    v_add_lshl_u32 v3, v3, v84, 4
    s_mul_i32 s44, s40, 4608
    v_add_u32 v3, s44, v3
    s_lshl_b32 s41, s41, 4
    s_lshl_b32 s44, s40, 2
    s_add_u32 s41, s41, s44
    s_lshl_b32 s41, s41, 5
    s_add_u32 s41, s41, s42
    s_lshl_b32 s41, s41, 10
    s_add_u32 s42, s41, 2097152
    buffer_load_dwordx4 v[68:71], v2, s[16:19], s42 offen
    s_add_u32 s42, s42, 32768
    buffer_load_dwordx4 v[72:75], v2, s[16:19], s42 offen
    s_add_u32 s42, s42, 32768
    buffer_load_dwordx4 v[76:79], v2, s[16:19], s42 offen
    s_add_u32 s42, s42, 32768
    buffer_load_dwordx4 v[80:83], v2, s[16:19], s42 offen
    s_waitcnt vmcnt(4)
    s_barrier
    ds_read_b128 v[4:7], v3 offset:8192
    ds_read_b128 v[8:11], v3 offset:8464
    ds_read_b128 v[12:15], v3 offset:9344
    ds_read_b128 v[16:19], v3 offset:9616
    ds_read_b128 v[20:23], v3 offset:10496
    ds_read_b128 v[24:27], v3 offset:10768
    ds_read_b128 v[28:31], v3 offset:11648
    ds_read_b128 v[32:35], v3 offset:11920
    s_waitcnt lgkmcnt(0)
    v_pk_add_f32 v[4:5], v[4:5], v[20:21]
    v_pk_add_f32 v[6:7], v[6:7], v[22:23]
    v_pk_add_f32 v[8:9], v[8:9], v[24:25]
    v_pk_add_f32 v[10:11], v[10:11], v[26:27]
    v_pk_add_f32 v[12:13], v[12:13], v[28:29]
    v_pk_add_f32 v[14:15], v[14:15], v[30:31]
    v_pk_add_f32 v[16:17], v[16:17], v[32:33]
    v_pk_add_f32 v[18:19], v[18:19], v[34:35]
    v_pk_add_f32 v[4:5], v[4:5], v[12:13]
    v_pk_add_f32 v[6:7], v[6:7], v[14:15]
    v_pk_add_f32 v[8:9], v[8:9], v[16:17]
    v_pk_add_f32 v[10:11], v[10:11], v[18:19]
    s_lshl_b32 s44, s40, 11
    v_add_u32 v3, s44, v2
    ds_write_b128 v3, v[4:7]
    ds_write_b128 v3, v[8:11] offset:1024
    s_waitcnt lgkmcnt(0)
    s_barrier
    ds_read_b128 v[12:15], v2 offset:0
    ds_read_b128 v[16:19], v2 offset:1024
    ds_read_b128 v[20:23], v2 offset:2048
    ds_read_b128 v[24:27], v2 offset:3072
    ds_read_b128 v[28:31], v2 offset:4096
    ds_read_b128 v[32:35], v2 offset:5120
    ds_read_b128 v[36:39], v2 offset:6144
    ds_read_b128 v[40:43], v2 offset:7168
    s_waitcnt lgkmcnt(0)
    v_pk_add_f32 v[12:13], v[12:13], v[20:21]
    v_pk_add_f32 v[14:15], v[14:15], v[22:23]
    v_pk_add_f32 v[16:17], v[16:17], v[24:25]
    v_pk_add_f32 v[18:19], v[18:19], v[26:27]
    v_pk_add_f32 v[28:29], v[28:29], v[36:37]
    v_pk_add_f32 v[30:31], v[30:31], v[38:39]
    v_pk_add_f32 v[32:33], v[32:33], v[40:41]
    v_pk_add_f32 v[34:35], v[34:35], v[42:43]
    v_pk_add_f32 v[12:13], v[12:13], v[28:29]
    v_pk_add_f32 v[14:15], v[14:15], v[30:31]
    v_pk_add_f32 v[16:17], v[16:17], v[32:33]
    v_pk_add_f32 v[18:19], v[18:19], v[34:35]
    v_cvt_pk_bf16_f32 v84, v12, v13
    v_cvt_pk_bf16_f32 v85, v14, v15
    v_cvt_pk_bf16_f32 v86, v16, v17
    v_cvt_pk_bf16_f32 v87, v18, v19
    s_waitcnt vmcnt(0)
    s_nop 0
    v_mfma_f32_32x32x16_bf16 v[88:103], v[84:87], v[68:71], 0
    v_mfma_f32_32x32x16_bf16 v[104:119], v[84:87], v[72:75], 0
    v_mfma_f32_32x32x16_bf16 v[120:135], v[84:87], v[76:79], 0
    v_mfma_f32_32x32x16_bf16 v[136:151], v[84:87], v[80:83], 0
    s_add_u32 s42, s41, 11534336
    s_nop 7
    v_cvt_pk_bf16_f32 v4, v96, v96
    v_lshlrev_b32 v4, 16, v4
    v_add_f32 v4, s48, v4
    v_cvt_pk_bf16_f32 v4, v4, v4
    v_lshlrev_b32 v4, 16, v4
    v_rcp_f32 v4, v4
    v_cvt_pk_bf16_f32 v8, v88, v89
    v_cvt_pk_bf16_f32 v9, v90, v91
    v_cvt_pk_bf16_f32 v10, v92, v93
    v_cvt_pk_bf16_f32 v11, v94, v95
    v_lshlrev_b32 v88, 16, v8
    v_and_b32 v89, 0xffff0000, v8
    v_lshlrev_b32 v90, 16, v9
    v_and_b32 v91, 0xffff0000, v9
    v_lshlrev_b32 v92, 16, v10
    v_and_b32 v93, 0xffff0000, v10
    v_lshlrev_b32 v94, 16, v11
    v_and_b32 v95, 0xffff0000, v11
    v_pk_mul_f32 v[88:89], v[88:89], v[4:5] op_sel_hi:[1,0]
    v_pk_mul_f32 v[90:91], v[90:91], v[4:5] op_sel_hi:[1,0]
    v_pk_mul_f32 v[92:93], v[92:93], v[4:5] op_sel_hi:[1,0]
    v_pk_mul_f32 v[94:95], v[94:95], v[4:5] op_sel_hi:[1,0]
    v_cvt_pk_bf16_f32 v12, v88, v89
    v_cvt_pk_bf16_f32 v13, v90, v91
    v_cvt_pk_bf16_f32 v14, v92, v93
    v_cvt_pk_bf16_f32 v15, v94, v95
    buffer_store_dwordx4 v[12:15], v2, s[16:19], s42 offen
    s_add_u32 s42, s42, 32768
    v_cvt_pk_bf16_f32 v20, v112, v112
    v_lshlrev_b32 v20, 16, v20
    v_add_f32 v20, s48, v20
    v_cvt_pk_bf16_f32 v20, v20, v20
    v_lshlrev_b32 v20, 16, v20
    v_rcp_f32 v20, v20
    v_cvt_pk_bf16_f32 v24, v104, v105
    v_cvt_pk_bf16_f32 v25, v106, v107
    v_cvt_pk_bf16_f32 v26, v108, v109
    v_cvt_pk_bf16_f32 v27, v110, v111
    v_lshlrev_b32 v104, 16, v24
    v_and_b32 v105, 0xffff0000, v24
    v_lshlrev_b32 v106, 16, v25
    v_and_b32 v107, 0xffff0000, v25
    v_lshlrev_b32 v108, 16, v26
    v_and_b32 v109, 0xffff0000, v26
    v_lshlrev_b32 v110, 16, v27
    v_and_b32 v111, 0xffff0000, v27
    v_pk_mul_f32 v[104:105], v[104:105], v[20:21] op_sel_hi:[1,0]
    v_pk_mul_f32 v[106:107], v[106:107], v[20:21] op_sel_hi:[1,0]
    v_pk_mul_f32 v[108:109], v[108:109], v[20:21] op_sel_hi:[1,0]
    v_pk_mul_f32 v[110:111], v[110:111], v[20:21] op_sel_hi:[1,0]
    v_cvt_pk_bf16_f32 v28, v104, v105
    v_cvt_pk_bf16_f32 v29, v106, v107
    v_cvt_pk_bf16_f32 v30, v108, v109
    v_cvt_pk_bf16_f32 v31, v110, v111
    buffer_store_dwordx4 v[28:31], v2, s[16:19], s42 offen
    s_add_u32 s42, s42, 32768
    v_cvt_pk_bf16_f32 v36, v128, v128
    v_lshlrev_b32 v36, 16, v36
    v_add_f32 v36, s48, v36
    v_cvt_pk_bf16_f32 v36, v36, v36
    v_lshlrev_b32 v36, 16, v36
    v_rcp_f32 v36, v36
    v_cvt_pk_bf16_f32 v40, v120, v121
    v_cvt_pk_bf16_f32 v41, v122, v123
    v_cvt_pk_bf16_f32 v42, v124, v125
    v_cvt_pk_bf16_f32 v43, v126, v127
    v_lshlrev_b32 v120, 16, v40
    v_and_b32 v121, 0xffff0000, v40
    v_lshlrev_b32 v122, 16, v41
    v_and_b32 v123, 0xffff0000, v41
    v_lshlrev_b32 v124, 16, v42
    v_and_b32 v125, 0xffff0000, v42
    v_lshlrev_b32 v126, 16, v43
    v_and_b32 v127, 0xffff0000, v43
    v_pk_mul_f32 v[120:121], v[120:121], v[36:37] op_sel_hi:[1,0]
    v_pk_mul_f32 v[122:123], v[122:123], v[36:37] op_sel_hi:[1,0]
    v_pk_mul_f32 v[124:125], v[124:125], v[36:37] op_sel_hi:[1,0]
    v_pk_mul_f32 v[126:127], v[126:127], v[36:37] op_sel_hi:[1,0]
    v_cvt_pk_bf16_f32 v44, v120, v121
    v_cvt_pk_bf16_f32 v45, v122, v123
    v_cvt_pk_bf16_f32 v46, v124, v125
    v_cvt_pk_bf16_f32 v47, v126, v127
    buffer_store_dwordx4 v[44:47], v2, s[16:19], s42 offen
    s_add_u32 s42, s42, 32768
    v_cvt_pk_bf16_f32 v52, v144, v144
    v_lshlrev_b32 v52, 16, v52
    v_add_f32 v52, s48, v52
    v_cvt_pk_bf16_f32 v52, v52, v52
    v_lshlrev_b32 v52, 16, v52
    v_rcp_f32 v52, v52
    v_cvt_pk_bf16_f32 v56, v136, v137
    v_cvt_pk_bf16_f32 v57, v138, v139
    v_cvt_pk_bf16_f32 v58, v140, v141
    v_cvt_pk_bf16_f32 v59, v142, v143
    v_lshlrev_b32 v136, 16, v56
    v_and_b32 v137, 0xffff0000, v56
    v_lshlrev_b32 v138, 16, v57
    v_and_b32 v139, 0xffff0000, v57
    v_lshlrev_b32 v140, 16, v58
    v_and_b32 v141, 0xffff0000, v58
    v_lshlrev_b32 v142, 16, v59
    v_and_b32 v143, 0xffff0000, v59
    v_pk_mul_f32 v[136:137], v[136:137], v[52:53] op_sel_hi:[1,0]
    v_pk_mul_f32 v[138:139], v[138:139], v[52:53] op_sel_hi:[1,0]
    v_pk_mul_f32 v[140:141], v[140:141], v[52:53] op_sel_hi:[1,0]
    v_pk_mul_f32 v[142:143], v[142:143], v[52:53] op_sel_hi:[1,0]
    v_cvt_pk_bf16_f32 v60, v136, v137
    v_cvt_pk_bf16_f32 v61, v138, v139
    v_cvt_pk_bf16_f32 v62, v140, v141
    v_cvt_pk_bf16_f32 v63, v142, v143
    buffer_store_dwordx4 v[60:63], v2, s[16:19], s42 offen
    s_endpgm
k2_gate:
    s_mov_b32 s32, s4
    s_mov_b32 s33, s5
    s_mov_b32 s34, 2097152
    s_mov_b32 s35, 0x00020000
    s_mov_b32 s36, s8
    s_mov_b32 s37, s9
    s_mov_b32 s38, 1024
    s_mov_b32 s39, 0x00020000
    s_sub_u32 s50, s2, 385
    s_lshl_b32 s50, s50, 2
    s_add_u32 s50, s50, s40
    s_mul_i32 s50, s50, 8192
    buffer_load_dwordx4 v[8:11], v2, s[36:39], 0 offen
    s_add_u32 s41, s50, 4096
    buffer_load_dwordx4 v[40:43], v2, s[32:35], s50 offen offset:0
    buffer_load_dwordx4 v[44:47], v2, s[32:35], s50 offen offset:1024
    buffer_load_dwordx4 v[48:51], v2, s[32:35], s50 offen offset:2048
    buffer_load_dwordx4 v[52:55], v2, s[32:35], s50 offen offset:3072
    buffer_load_dwordx4 v[56:59], v2, s[32:35], s41 offen offset:0
    buffer_load_dwordx4 v[60:63], v2, s[32:35], s41 offen offset:1024
    buffer_load_dwordx4 v[64:67], v2, s[32:35], s41 offen offset:2048
    buffer_load_dwordx4 v[68:71], v2, s[32:35], s41 offen offset:3072
    v_and_b32 v4, 31, v1
    v_min_u32 v4, 1, v4
    v_lshlrev_b32 v4, 30, v4
    v_lshrrev_b32 v5, 5, v1
    v_lshl_add_u32 v4, v5, 3, v4
    s_lshr_b32 s41, s50, 7
    s_add_u32 s41, s41, 14680064
    s_waitcnt vmcnt(8)
    s_setprio 2
    v_lshlrev_b32 v24, 16, v8
    v_and_b32 v25, 0xffff0000, v8
    v_lshlrev_b32 v26, 16, v9
    v_and_b32 v27, 0xffff0000, v9
    v_lshlrev_b32 v28, 16, v10
    v_and_b32 v29, 0xffff0000, v10
    v_lshlrev_b32 v30, 16, v11
    v_and_b32 v31, 0xffff0000, v11
    s_waitcnt vmcnt(7)
    v_lshlrev_b32 v72, 16, v40
    v_and_b32 v73, 0xffff0000, v40
    v_lshlrev_b32 v74, 16, v41
    v_and_b32 v75, 0xffff0000, v41
    v_lshlrev_b32 v76, 16, v42
    v_and_b32 v77, 0xffff0000, v42
    v_lshlrev_b32 v78, 16, v43
    v_and_b32 v79, 0xffff0000, v43
    v_pk_mul_f32 v[72:73], v[72:73], v[24:25]
    v_pk_mul_f32 v[74:75], v[74:75], v[26:27]
    v_pk_mul_f32 v[76:77], v[76:77], v[28:29]
    v_pk_mul_f32 v[78:79], v[78:79], v[30:31]
    v_cvt_pk_bf16_f32 v80, v72, v73
    v_cvt_pk_bf16_f32 v81, v74, v75
    v_cvt_pk_bf16_f32 v82, v76, v77
    v_cvt_pk_bf16_f32 v83, v78, v79
    v_lshlrev_b32 v72, 16, v80
    v_and_b32 v73, 0xffff0000, v80
    v_lshlrev_b32 v74, 16, v81
    v_and_b32 v75, 0xffff0000, v81
    v_lshlrev_b32 v76, 16, v82
    v_and_b32 v77, 0xffff0000, v82
    v_lshlrev_b32 v78, 16, v83
    v_and_b32 v79, 0xffff0000, v83
    v_pk_add_f32 v[72:73], v[72:73], v[76:77]
    v_pk_add_f32 v[74:75], v[74:75], v[78:79]
    v_pk_add_f32 v[72:73], v[72:73], v[74:75]
    v_add_f32 v16, v72, v73
    s_waitcnt vmcnt(6)
    v_lshlrev_b32 v72, 16, v44
    v_and_b32 v73, 0xffff0000, v44
    v_lshlrev_b32 v74, 16, v45
    v_and_b32 v75, 0xffff0000, v45
    v_lshlrev_b32 v76, 16, v46
    v_and_b32 v77, 0xffff0000, v46
    v_lshlrev_b32 v78, 16, v47
    v_and_b32 v79, 0xffff0000, v47
    v_pk_mul_f32 v[72:73], v[72:73], v[24:25]
    v_pk_mul_f32 v[74:75], v[74:75], v[26:27]
    v_pk_mul_f32 v[76:77], v[76:77], v[28:29]
    v_pk_mul_f32 v[78:79], v[78:79], v[30:31]
    v_cvt_pk_bf16_f32 v80, v72, v73
    v_cvt_pk_bf16_f32 v81, v74, v75
    v_cvt_pk_bf16_f32 v82, v76, v77
    v_cvt_pk_bf16_f32 v83, v78, v79
    v_lshlrev_b32 v72, 16, v80
    v_and_b32 v73, 0xffff0000, v80
    v_lshlrev_b32 v74, 16, v81
    v_and_b32 v75, 0xffff0000, v81
    v_lshlrev_b32 v76, 16, v82
    v_and_b32 v77, 0xffff0000, v82
    v_lshlrev_b32 v78, 16, v83
    v_and_b32 v79, 0xffff0000, v83
    v_pk_add_f32 v[72:73], v[72:73], v[76:77]
    v_pk_add_f32 v[74:75], v[74:75], v[78:79]
    v_pk_add_f32 v[72:73], v[72:73], v[74:75]
    v_add_f32 v17, v72, v73
    s_waitcnt vmcnt(5)
    v_lshlrev_b32 v72, 16, v48
    v_and_b32 v73, 0xffff0000, v48
    v_lshlrev_b32 v74, 16, v49
    v_and_b32 v75, 0xffff0000, v49
    v_lshlrev_b32 v76, 16, v50
    v_and_b32 v77, 0xffff0000, v50
    v_lshlrev_b32 v78, 16, v51
    v_and_b32 v79, 0xffff0000, v51
    v_pk_mul_f32 v[72:73], v[72:73], v[24:25]
    v_pk_mul_f32 v[74:75], v[74:75], v[26:27]
    v_pk_mul_f32 v[76:77], v[76:77], v[28:29]
    v_pk_mul_f32 v[78:79], v[78:79], v[30:31]
    v_cvt_pk_bf16_f32 v80, v72, v73
    v_cvt_pk_bf16_f32 v81, v74, v75
    v_cvt_pk_bf16_f32 v82, v76, v77
    v_cvt_pk_bf16_f32 v83, v78, v79
    v_lshlrev_b32 v72, 16, v80
    v_and_b32 v73, 0xffff0000, v80
    v_lshlrev_b32 v74, 16, v81
    v_and_b32 v75, 0xffff0000, v81
    v_lshlrev_b32 v76, 16, v82
    v_and_b32 v77, 0xffff0000, v82
    v_lshlrev_b32 v78, 16, v83
    v_and_b32 v79, 0xffff0000, v83
    v_pk_add_f32 v[72:73], v[72:73], v[76:77]
    v_pk_add_f32 v[74:75], v[74:75], v[78:79]
    v_pk_add_f32 v[72:73], v[72:73], v[74:75]
    v_add_f32 v18, v72, v73
    s_waitcnt vmcnt(4)
    v_lshlrev_b32 v72, 16, v52
    v_and_b32 v73, 0xffff0000, v52
    v_lshlrev_b32 v74, 16, v53
    v_and_b32 v75, 0xffff0000, v53
    v_lshlrev_b32 v76, 16, v54
    v_and_b32 v77, 0xffff0000, v54
    v_lshlrev_b32 v78, 16, v55
    v_and_b32 v79, 0xffff0000, v55
    v_pk_mul_f32 v[72:73], v[72:73], v[24:25]
    v_pk_mul_f32 v[74:75], v[74:75], v[26:27]
    v_pk_mul_f32 v[76:77], v[76:77], v[28:29]
    v_pk_mul_f32 v[78:79], v[78:79], v[30:31]
    v_cvt_pk_bf16_f32 v80, v72, v73
    v_cvt_pk_bf16_f32 v81, v74, v75
    v_cvt_pk_bf16_f32 v82, v76, v77
    v_cvt_pk_bf16_f32 v83, v78, v79
    v_lshlrev_b32 v72, 16, v80
    v_and_b32 v73, 0xffff0000, v80
    v_lshlrev_b32 v74, 16, v81
    v_and_b32 v75, 0xffff0000, v81
    v_lshlrev_b32 v76, 16, v82
    v_and_b32 v77, 0xffff0000, v82
    v_lshlrev_b32 v78, 16, v83
    v_and_b32 v79, 0xffff0000, v83
    v_pk_add_f32 v[72:73], v[72:73], v[76:77]
    v_pk_add_f32 v[74:75], v[74:75], v[78:79]
    v_pk_add_f32 v[72:73], v[72:73], v[74:75]
    v_add_f32 v19, v72, v73
    s_waitcnt vmcnt(3)
    v_lshlrev_b32 v72, 16, v56
    v_and_b32 v73, 0xffff0000, v56
    v_lshlrev_b32 v74, 16, v57
    v_and_b32 v75, 0xffff0000, v57
    v_lshlrev_b32 v76, 16, v58
    v_and_b32 v77, 0xffff0000, v58
    v_lshlrev_b32 v78, 16, v59
    v_and_b32 v79, 0xffff0000, v59
    v_pk_mul_f32 v[72:73], v[72:73], v[24:25]
    v_pk_mul_f32 v[74:75], v[74:75], v[26:27]
    v_pk_mul_f32 v[76:77], v[76:77], v[28:29]
    v_pk_mul_f32 v[78:79], v[78:79], v[30:31]
    v_cvt_pk_bf16_f32 v80, v72, v73
    v_cvt_pk_bf16_f32 v81, v74, v75
    v_cvt_pk_bf16_f32 v82, v76, v77
    v_cvt_pk_bf16_f32 v83, v78, v79
    v_lshlrev_b32 v72, 16, v80
    v_and_b32 v73, 0xffff0000, v80
    v_lshlrev_b32 v74, 16, v81
    v_and_b32 v75, 0xffff0000, v81
    v_lshlrev_b32 v76, 16, v82
    v_and_b32 v77, 0xffff0000, v82
    v_lshlrev_b32 v78, 16, v83
    v_and_b32 v79, 0xffff0000, v83
    v_pk_add_f32 v[72:73], v[72:73], v[76:77]
    v_pk_add_f32 v[74:75], v[74:75], v[78:79]
    v_pk_add_f32 v[72:73], v[72:73], v[74:75]
    v_add_f32 v20, v72, v73
    s_waitcnt vmcnt(2)
    v_lshlrev_b32 v72, 16, v60
    v_and_b32 v73, 0xffff0000, v60
    v_lshlrev_b32 v74, 16, v61
    v_and_b32 v75, 0xffff0000, v61
    v_lshlrev_b32 v76, 16, v62
    v_and_b32 v77, 0xffff0000, v62
    v_lshlrev_b32 v78, 16, v63
    v_and_b32 v79, 0xffff0000, v63
    v_pk_mul_f32 v[72:73], v[72:73], v[24:25]
    v_pk_mul_f32 v[74:75], v[74:75], v[26:27]
    v_pk_mul_f32 v[76:77], v[76:77], v[28:29]
    v_pk_mul_f32 v[78:79], v[78:79], v[30:31]
    v_cvt_pk_bf16_f32 v80, v72, v73
    v_cvt_pk_bf16_f32 v81, v74, v75
    v_cvt_pk_bf16_f32 v82, v76, v77
    v_cvt_pk_bf16_f32 v83, v78, v79
    v_lshlrev_b32 v72, 16, v80
    v_and_b32 v73, 0xffff0000, v80
    v_lshlrev_b32 v74, 16, v81
    v_and_b32 v75, 0xffff0000, v81
    v_lshlrev_b32 v76, 16, v82
    v_and_b32 v77, 0xffff0000, v82
    v_lshlrev_b32 v78, 16, v83
    v_and_b32 v79, 0xffff0000, v83
    v_pk_add_f32 v[72:73], v[72:73], v[76:77]
    v_pk_add_f32 v[74:75], v[74:75], v[78:79]
    v_pk_add_f32 v[72:73], v[72:73], v[74:75]
    v_add_f32 v21, v72, v73
    s_waitcnt vmcnt(1)
    v_lshlrev_b32 v72, 16, v64
    v_and_b32 v73, 0xffff0000, v64
    v_lshlrev_b32 v74, 16, v65
    v_and_b32 v75, 0xffff0000, v65
    v_lshlrev_b32 v76, 16, v66
    v_and_b32 v77, 0xffff0000, v66
    v_lshlrev_b32 v78, 16, v67
    v_and_b32 v79, 0xffff0000, v67
    v_pk_mul_f32 v[72:73], v[72:73], v[24:25]
    v_pk_mul_f32 v[74:75], v[74:75], v[26:27]
    v_pk_mul_f32 v[76:77], v[76:77], v[28:29]
    v_pk_mul_f32 v[78:79], v[78:79], v[30:31]
    v_cvt_pk_bf16_f32 v80, v72, v73
    v_cvt_pk_bf16_f32 v81, v74, v75
    v_cvt_pk_bf16_f32 v82, v76, v77
    v_cvt_pk_bf16_f32 v83, v78, v79
    v_lshlrev_b32 v72, 16, v80
    v_and_b32 v73, 0xffff0000, v80
    v_lshlrev_b32 v74, 16, v81
    v_and_b32 v75, 0xffff0000, v81
    v_lshlrev_b32 v76, 16, v82
    v_and_b32 v77, 0xffff0000, v82
    v_lshlrev_b32 v78, 16, v83
    v_and_b32 v79, 0xffff0000, v83
    v_pk_add_f32 v[72:73], v[72:73], v[76:77]
    v_pk_add_f32 v[74:75], v[74:75], v[78:79]
    v_pk_add_f32 v[72:73], v[72:73], v[74:75]
    v_add_f32 v22, v72, v73
    s_waitcnt vmcnt(0)
    v_lshlrev_b32 v72, 16, v68
    v_and_b32 v73, 0xffff0000, v68
    v_lshlrev_b32 v74, 16, v69
    v_and_b32 v75, 0xffff0000, v69
    v_lshlrev_b32 v76, 16, v70
    v_and_b32 v77, 0xffff0000, v70
    v_lshlrev_b32 v78, 16, v71
    v_and_b32 v79, 0xffff0000, v71
    v_pk_mul_f32 v[72:73], v[72:73], v[24:25]
    v_pk_mul_f32 v[74:75], v[74:75], v[26:27]
    v_pk_mul_f32 v[76:77], v[76:77], v[28:29]
    v_pk_mul_f32 v[78:79], v[78:79], v[30:31]
    v_cvt_pk_bf16_f32 v80, v72, v73
    v_cvt_pk_bf16_f32 v81, v74, v75
    v_cvt_pk_bf16_f32 v82, v76, v77
    v_cvt_pk_bf16_f32 v83, v78, v79
    v_lshlrev_b32 v72, 16, v80
    v_and_b32 v73, 0xffff0000, v80
    v_lshlrev_b32 v74, 16, v81
    v_and_b32 v75, 0xffff0000, v81
    v_lshlrev_b32 v76, 16, v82
    v_and_b32 v77, 0xffff0000, v82
    v_lshlrev_b32 v78, 16, v83
    v_and_b32 v79, 0xffff0000, v83
    v_pk_add_f32 v[72:73], v[72:73], v[76:77]
    v_pk_add_f32 v[74:75], v[74:75], v[78:79]
    v_pk_add_f32 v[72:73], v[72:73], v[74:75]
    v_add_f32 v23, v72, v73
    v_add_f32_dpp v16, v16, v16 row_ror:8 row_mask:0xf bank_mask:0xf
    v_add_f32_dpp v17, v17, v17 row_ror:8 row_mask:0xf bank_mask:0xf
    v_add_f32_dpp v18, v18, v18 row_ror:8 row_mask:0xf bank_mask:0xf
    v_add_f32_dpp v19, v19, v19 row_ror:8 row_mask:0xf bank_mask:0xf
    v_add_f32_dpp v20, v20, v20 row_ror:8 row_mask:0xf bank_mask:0xf
    v_add_f32_dpp v21, v21, v21 row_ror:8 row_mask:0xf bank_mask:0xf
    v_add_f32_dpp v22, v22, v22 row_ror:8 row_mask:0xf bank_mask:0xf
    v_add_f32_dpp v23, v23, v23 row_ror:8 row_mask:0xf bank_mask:0xf
    v_add_f32_dpp v16, v16, v16 row_ror:4 row_mask:0xf bank_mask:0xf
    v_add_f32_dpp v17, v17, v17 row_ror:4 row_mask:0xf bank_mask:0xf
    v_add_f32_dpp v18, v18, v18 row_ror:4 row_mask:0xf bank_mask:0xf
    v_add_f32_dpp v19, v19, v19 row_ror:4 row_mask:0xf bank_mask:0xf
    v_add_f32_dpp v20, v20, v20 row_ror:4 row_mask:0xf bank_mask:0xf
    v_add_f32_dpp v21, v21, v21 row_ror:4 row_mask:0xf bank_mask:0xf
    v_add_f32_dpp v22, v22, v22 row_ror:4 row_mask:0xf bank_mask:0xf
    v_add_f32_dpp v23, v23, v23 row_ror:4 row_mask:0xf bank_mask:0xf
    v_add_f32_dpp v16, v16, v16 row_ror:2 row_mask:0xf bank_mask:0xf
    v_add_f32_dpp v17, v17, v17 row_ror:2 row_mask:0xf bank_mask:0xf
    v_add_f32_dpp v18, v18, v18 row_ror:2 row_mask:0xf bank_mask:0xf
    v_add_f32_dpp v19, v19, v19 row_ror:2 row_mask:0xf bank_mask:0xf
    v_add_f32_dpp v20, v20, v20 row_ror:2 row_mask:0xf bank_mask:0xf
    v_add_f32_dpp v21, v21, v21 row_ror:2 row_mask:0xf bank_mask:0xf
    v_add_f32_dpp v22, v22, v22 row_ror:2 row_mask:0xf bank_mask:0xf
    v_add_f32_dpp v23, v23, v23 row_ror:2 row_mask:0xf bank_mask:0xf
    v_add_f32_dpp v16, v16, v16 row_ror:1 row_mask:0xf bank_mask:0xf
    v_add_f32_dpp v17, v17, v17 row_ror:1 row_mask:0xf bank_mask:0xf
    v_add_f32_dpp v18, v18, v18 row_ror:1 row_mask:0xf bank_mask:0xf
    v_add_f32_dpp v19, v19, v19 row_ror:1 row_mask:0xf bank_mask:0xf
    v_add_f32_dpp v20, v20, v20 row_ror:1 row_mask:0xf bank_mask:0xf
    v_add_f32_dpp v21, v21, v21 row_ror:1 row_mask:0xf bank_mask:0xf
    v_add_f32_dpp v22, v22, v22 row_ror:1 row_mask:0xf bank_mask:0xf
    v_add_f32_dpp v23, v23, v23 row_ror:1 row_mask:0xf bank_mask:0xf
    v_mov_b32 v72, v16
    v_mov_b32 v73, v17
    v_mov_b32 v74, v18
    v_mov_b32 v75, v19
    v_mov_b32 v76, v20
    v_mov_b32 v77, v21
    v_mov_b32 v78, v22
    v_mov_b32 v79, v23
    v_permlane16_swap_b32 v72, v16
    v_permlane16_swap_b32 v73, v17
    v_permlane16_swap_b32 v74, v18
    v_permlane16_swap_b32 v75, v19
    v_permlane16_swap_b32 v76, v20
    v_permlane16_swap_b32 v77, v21
    v_permlane16_swap_b32 v78, v22
    v_permlane16_swap_b32 v79, v23
    v_add_f32 v16, v16, v72
    v_add_f32 v17, v17, v73
    v_add_f32 v18, v18, v74
    v_add_f32 v19, v19, v75
    v_add_f32 v20, v20, v76
    v_add_f32 v21, v21, v77
    v_add_f32 v22, v22, v78
    v_add_f32 v23, v23, v79
    v_permlane32_swap_b32 v16, v17
    v_permlane32_swap_b32 v18, v19
    v_permlane32_swap_b32 v20, v21
    v_permlane32_swap_b32 v22, v23
    v_add_f32 v72, v16, v17
    v_add_f32 v74, v18, v19
    v_add_f32 v76, v20, v21
    v_add_f32 v78, v22, v23
    v_cvt_pk_bf16_f32 v72, v72, v72
    v_cvt_pk_bf16_f32 v74, v74, v74
    v_cvt_pk_bf16_f32 v76, v76, v76
    v_cvt_pk_bf16_f32 v78, v78, v78
    v_lshlrev_b32 v72, 16, v72
    v_lshlrev_b32 v74, 16, v74
    v_lshlrev_b32 v76, 16, v76
    v_lshlrev_b32 v78, 16, v78
    v_mul_f32 v72, s47, v72
    v_mul_f32 v74, s47, v74
    v_mul_f32 v76, s47, v76
    v_mul_f32 v78, s47, v78
    v_exp_f32 v72, -v72
    v_exp_f32 v74, -v74
    v_exp_f32 v76, -v76
    v_exp_f32 v78, -v78
    v_add_f32 v72, 1.0, v72
    v_add_f32 v74, 1.0, v74
    v_add_f32 v76, 1.0, v76
    v_add_f32 v78, 1.0, v78
    v_rcp_f32 v72, v72
    v_rcp_f32 v74, v74
    v_rcp_f32 v76, v76
    v_rcp_f32 v78, v78
    v_cvt_pk_bf16_f32 v72, v72, v72
    v_cvt_pk_bf16_f32 v74, v74, v74
    v_cvt_pk_bf16_f32 v76, v76, v76
    v_cvt_pk_bf16_f32 v78, v78, v78
    v_lshlrev_b32 v72, 16, v72
    v_lshlrev_b32 v74, 16, v74
    v_lshlrev_b32 v76, 16, v76
    v_lshlrev_b32 v78, 16, v78
    v_sub_f32 v73, 1.0, v72
    v_sub_f32 v75, 1.0, v74
    v_sub_f32 v77, 1.0, v76
    v_sub_f32 v79, 1.0, v78
    v_cvt_pk_bf16_f32 v73, v73, v73
    v_cvt_pk_bf16_f32 v75, v75, v75
    v_cvt_pk_bf16_f32 v77, v77, v77
    v_cvt_pk_bf16_f32 v79, v79, v79
    v_lshlrev_b32 v73, 16, v73
    v_lshlrev_b32 v75, 16, v75
    v_lshlrev_b32 v77, 16, v77
    v_lshlrev_b32 v79, 16, v79
    v_mul_f32 v73, 0x36000000, v73
    v_mul_f32 v75, 0x36000000, v75
    v_mul_f32 v77, 0x36000000, v77
    v_mul_f32 v79, 0x36000000, v79
    buffer_store_dwordx2 v[72:73], v4, s[16:19], s41 offen offset:0
    buffer_store_dwordx2 v[74:75], v4, s[16:19], s41 offen offset:16
    buffer_store_dwordx2 v[76:77], v4, s[16:19], s41 offen offset:32
    buffer_store_dwordx2 v[78:79], v4, s[16:19], s41 offen offset:48
    s_endpgm
k2_end:
    s_endpgm
.globl k3_kernel
.p2align 8
.type k3_kernel,@function
k3_kernel:
    s_cmp_ge_u32 s2, 256
    s_cbranch_scc1 k3_end
    s_load_dwordx2 s[12:13], s[0:1], 72
    s_load_dwordx2 s[4:5], s[0:1], 56
    s_getpc_b64 s[20:21]
    s_add_u32 s20, s20, k3_kernel@rel32@lo+4
    s_addc_u32 s21, s21, k3_kernel@rel32@hi+12
    s_mov_b32 s22, (k3_code_end-k3_kernel)
    s_mov_b32 s23, 0x00020000
    v_lshlrev_b32 v3, 6, v0
    buffer_load_dword a255, v3, s[20:23], 0 offen
    v_and_b32 v1, 63, v0
    v_lshrrev_b32 v3, 6, v0
    v_lshlrev_b32 v2, 4, v1
    v_readfirstlane_b32 s40, v3
    s_and_b32 s43, s2, 7
    s_lshr_b32 s44, s2, 3
    s_lshl_b32 s41, s43, 2
    s_and_b32 s43, s44, 3
    s_add_u32 s41, s41, s43
    s_lshr_b32 s42, s44, 2
    s_lshl_b32 s43, s43, 1
    s_add_u32 s48, s42, s43
    s_lshl_b32 s43, s40, 17
    s_lshl_b32 s44, s42, 11
    s_add_u32 s43, s43, s44
    s_add_u32 s43, s43, 13631488
    s_lshl_b32 s44, s41, 16
    s_lshl_b32 s45, s40, 13
    s_add_u32 s44, s44, s45
    s_add_u32 s44, s44, 11534336
    s_add_u32 s45, s44, 32768
    s_lshr_b32 s62, s40, 1
    s_and_b32 s63, s40, 1
    s_cselect_b32 s46, s45, s44
    s_cselect_b32 s45, s44, s45
    s_mov_b32 s44, s46
    s_lshl_b32 s46, s62, 10
    s_add_u32 s43, s43, s46
    s_lshl_b32 s3, s62, 11
    s_sub_u32 s3, 1024, s3
    s_lshl_b32 s53, s40, 19
    s_lshl_b32 s46, s41, 7
    s_add_u32 s53, s53, s46
    s_add_u32 s53, s53, 9437184
    s_lshl_b32 s47, s40, 14
    v_lshrrev_b32 v11, 3, v1
    v_bfe_u32 v12, v1, 4, 1
    v_lshlrev_b32 v12, 2, v12
    v_and_b32 v13, 7, v1
    v_xor_b32 v12, v12, v13
    v_lshlrev_b32 v12, 4, v12
    v_lshl_add_u32 v10, v11, 12, v12
    s_waitcnt lgkmcnt(0)
    s_mov_b32 s16, s12
    s_mov_b32 s17, s13
    s_mov_b32 s18, 16777216
    s_mov_b32 s19, 0x00020000
    s_add_u32 s49, s48, 0
    s_and_b32 s49, s49, 7
    s_add_u32 m0, s47, 0
    s_lshl_b32 s51, s49, 16
    s_add_u32 s51, s51, s53
    s_add_u32 s52, s51, 31744
    buffer_load_dwordx4 v10, s[16:19], s51 offen lds
    buffer_load_dwordx4 v10, s[16:19], s52 offen offset:1024 lds
    s_add_u32 s49, s48, 0
    s_and_b32 s49, s49, 7
    s_lshl_b32 s50, s49, 14
    s_add_u32 s50, s50, s43
    s_lshl_b32 s51, s49, 10
    s_add_u32 s52, s51, s45
    s_add_u32 s51, s51, s44
    buffer_load_dwordx4 a[0:3], v2, s[16:19], s50 offen
    s_add_u32 s50, s50, s3
    buffer_load_dwordx4 a[4:7], v2, s[16:19], s50 offen
    buffer_load_dwordx4 a[8:11], v2, s[16:19], s51 offen
    buffer_load_dwordx4 a[12:15], v2, s[16:19], s52 offen
    v_bfe_u32 v11, v1, 3, 2
    v_lshlrev_b32 v11, 2, v11
    v_bfe_u32 v12, v1, 2, 1
    v_lshl_add_u32 v11, v12, 4, v11
    v_and_b32 v12, 3, v1
    s_lshl_b32 s46, s42, 6
    v_add3_u32 v11, v11, v12, s46
    s_lshl_b32 s46, s62, 5
    v_xor_b32 v11, s46, v11
    v_xor_b32 v12, 32, v11
    v_cvt_f32_u32 v16, v11
    v_cvt_f32_u32 v17, v12
    v_mul_f32 v16, 0x3b000000, v16
    v_mul_f32 v17, 0x3b000000, v17
    v_cos_f32 v18, v16
    v_cos_f32 v19, v17
    v_lshrrev_b32 v12, 5, v1
    v_lshlrev_b32 v13, 3, v12
    v_cvt_f32_u32 v13, v13
    v_add_f32 v18, v18, v18
    v_add_f32 v19, v19, v19
    s_and_b32 s60, s40, 1
    s_lshl_b32 s60, s60, 3
    s_cmp_lt_u32 s40, 2
    s_cselect_b32 s46, 0, 0x3e800000
    v_mov_b32 v14, s46
    v_fma_f32 v20, v16, v13, v14
    v_fma_f32 v21, v17, v13, v14
    v_and_b32 v14, 1, v11
    s_cselect_b32 s46, 1, 0
    v_or_b32 v14, s46, v14
    v_lshlrev_b32 v14, 31, v14
    v_or_b32 v14, 0.5, v14
    v_subrev_u32 v12, 1, v12
    v_and_b32 v22, v14, v12
    v_mov_b32 v23, v22
    s_add_u32 s49, s48, 0
    s_and_b32 s49, s49, 7
    s_or_b32 s49, s49, s60
    s_cselect_b32 s54, 0, 1.0
    s_mov_b32 s55, s54
    s_lshl_b32 s49, s49, 4
    v_cvt_f32_u32 v24, s49
    s_add_u32 s57, s48, 1
    s_and_b32 s57, s57, 7
    s_or_b32 s57, s57, s60
    s_cselect_b32 s58, 0, 1.0
    s_mov_b32 s59, s58
    s_lshl_b32 s57, s57, 4
    v_cvt_f32_u32 v26, s57
    v_pk_fma_f32 v[32:33], v[16:17], v[24:25], v[20:21] op_sel_hi:[1,0,1]
    v_pk_fma_f32 v[48:49], v[16:17], v[26:27], v[20:21] op_sel_hi:[1,0,1]
    v_pk_add_f32 v[34:35], v[32:33], v[16:17]
    v_pk_add_f32 v[50:51], v[48:49], v[16:17]
    v_cos_f32 v32, v32
    v_cos_f32 v33, v33
    v_cos_f32 v34, v34
    v_cos_f32 v35, v35
    v_cos_f32 v48, v48
    v_cos_f32 v49, v49
    v_cos_f32 v50, v50
    v_cos_f32 v51, v51
    v_pk_fma_f32 v[36:37], v[18:19], v[34:35], v[32:33] neg_lo:[0,0,1] neg_hi:[0,0,1]
    v_pk_fma_f32 v[52:53], v[18:19], v[50:51], v[48:49] neg_lo:[0,0,1] neg_hi:[0,0,1]
    v_pk_fma_f32 v[32:33], v[22:23], s[54:55], v[32:33]
    v_pk_fma_f32 v[48:49], v[22:23], s[58:59], v[48:49]
    v_pk_fma_f32 v[38:39], v[18:19], v[36:37], v[34:35] neg_lo:[0,0,1] neg_hi:[0,0,1]
    v_pk_fma_f32 v[54:55], v[18:19], v[52:53], v[50:51] neg_lo:[0,0,1] neg_hi:[0,0,1]
    v_pk_fma_f32 v[40:41], v[18:19], v[38:39], v[36:37] neg_lo:[0,0,1] neg_hi:[0,0,1]
    v_pk_fma_f32 v[56:57], v[18:19], v[54:55], v[52:53] neg_lo:[0,0,1] neg_hi:[0,0,1]
    v_pk_fma_f32 v[42:43], v[18:19], v[40:41], v[38:39] neg_lo:[0,0,1] neg_hi:[0,0,1]
    v_pk_fma_f32 v[58:59], v[18:19], v[56:57], v[54:55] neg_lo:[0,0,1] neg_hi:[0,0,1]
    v_pk_fma_f32 v[44:45], v[18:19], v[42:43], v[40:41] neg_lo:[0,0,1] neg_hi:[0,0,1]
    v_pk_fma_f32 v[60:61], v[18:19], v[58:59], v[56:57] neg_lo:[0,0,1] neg_hi:[0,0,1]
    v_pk_fma_f32 v[46:47], v[18:19], v[44:45], v[42:43] neg_lo:[0,0,1] neg_hi:[0,0,1]
    v_pk_fma_f32 v[62:63], v[18:19], v[60:61], v[58:59] neg_lo:[0,0,1] neg_hi:[0,0,1]
    v_cvt_pk_bf16_f32 v64, v32, v34
    v_cvt_pk_bf16_f32 v65, v36, v38
    v_cvt_pk_bf16_f32 v66, v40, v42
    v_cvt_pk_bf16_f32 v67, v44, v46
    v_cvt_pk_bf16_f32 v68, v33, v35
    v_cvt_pk_bf16_f32 v69, v37, v39
    v_cvt_pk_bf16_f32 v70, v41, v43
    v_cvt_pk_bf16_f32 v71, v45, v47
    v_cvt_pk_bf16_f32 v72, v48, v50
    v_cvt_pk_bf16_f32 v73, v52, v54
    v_cvt_pk_bf16_f32 v74, v56, v58
    v_cvt_pk_bf16_f32 v75, v60, v62
    v_cvt_pk_bf16_f32 v76, v49, v51
    v_cvt_pk_bf16_f32 v77, v53, v55
    v_cvt_pk_bf16_f32 v78, v57, v59
    v_cvt_pk_bf16_f32 v79, v61, v63
    s_add_u32 s49, s48, 2
    s_and_b32 s49, s49, 7
    s_or_b32 s49, s49, s60
    s_cselect_b32 s54, 0, 1.0
    s_mov_b32 s55, s54
    s_lshl_b32 s49, s49, 4
    v_cvt_f32_u32 v24, s49
    s_add_u32 s57, s48, 3
    s_and_b32 s57, s57, 7
    s_or_b32 s57, s57, s60
    s_cselect_b32 s58, 0, 1.0
    s_mov_b32 s59, s58
    s_lshl_b32 s57, s57, 4
    v_cvt_f32_u32 v26, s57
    v_pk_fma_f32 v[32:33], v[16:17], v[24:25], v[20:21] op_sel_hi:[1,0,1]
    v_pk_fma_f32 v[48:49], v[16:17], v[26:27], v[20:21] op_sel_hi:[1,0,1]
    v_pk_add_f32 v[34:35], v[32:33], v[16:17]
    v_pk_add_f32 v[50:51], v[48:49], v[16:17]
    v_cos_f32 v32, v32
    v_cos_f32 v33, v33
    v_cos_f32 v34, v34
    v_cos_f32 v35, v35
    v_cos_f32 v48, v48
    v_cos_f32 v49, v49
    v_cos_f32 v50, v50
    v_cos_f32 v51, v51
    v_pk_fma_f32 v[36:37], v[18:19], v[34:35], v[32:33] neg_lo:[0,0,1] neg_hi:[0,0,1]
    v_pk_fma_f32 v[52:53], v[18:19], v[50:51], v[48:49] neg_lo:[0,0,1] neg_hi:[0,0,1]
    v_pk_fma_f32 v[32:33], v[22:23], s[54:55], v[32:33]
    v_pk_fma_f32 v[48:49], v[22:23], s[58:59], v[48:49]
    v_pk_fma_f32 v[38:39], v[18:19], v[36:37], v[34:35] neg_lo:[0,0,1] neg_hi:[0,0,1]
    v_pk_fma_f32 v[54:55], v[18:19], v[52:53], v[50:51] neg_lo:[0,0,1] neg_hi:[0,0,1]
    v_pk_fma_f32 v[40:41], v[18:19], v[38:39], v[36:37] neg_lo:[0,0,1] neg_hi:[0,0,1]
    v_pk_fma_f32 v[56:57], v[18:19], v[54:55], v[52:53] neg_lo:[0,0,1] neg_hi:[0,0,1]
    v_pk_fma_f32 v[42:43], v[18:19], v[40:41], v[38:39] neg_lo:[0,0,1] neg_hi:[0,0,1]
    v_pk_fma_f32 v[58:59], v[18:19], v[56:57], v[54:55] neg_lo:[0,0,1] neg_hi:[0,0,1]
    v_pk_fma_f32 v[44:45], v[18:19], v[42:43], v[40:41] neg_lo:[0,0,1] neg_hi:[0,0,1]
    v_pk_fma_f32 v[60:61], v[18:19], v[58:59], v[56:57] neg_lo:[0,0,1] neg_hi:[0,0,1]
    v_pk_fma_f32 v[46:47], v[18:19], v[44:45], v[42:43] neg_lo:[0,0,1] neg_hi:[0,0,1]
    v_pk_fma_f32 v[62:63], v[18:19], v[60:61], v[58:59] neg_lo:[0,0,1] neg_hi:[0,0,1]
    v_cvt_pk_bf16_f32 v80, v32, v34
    v_cvt_pk_bf16_f32 v81, v36, v38
    v_cvt_pk_bf16_f32 v82, v40, v42
    v_cvt_pk_bf16_f32 v83, v44, v46
    v_cvt_pk_bf16_f32 v84, v33, v35
    v_cvt_pk_bf16_f32 v85, v37, v39
    v_cvt_pk_bf16_f32 v86, v41, v43
    v_cvt_pk_bf16_f32 v87, v45, v47
    v_cvt_pk_bf16_f32 v88, v48, v50
    v_cvt_pk_bf16_f32 v89, v52, v54
    v_cvt_pk_bf16_f32 v90, v56, v58
    v_cvt_pk_bf16_f32 v91, v60, v62
    v_cvt_pk_bf16_f32 v92, v49, v51
    v_cvt_pk_bf16_f32 v93, v53, v55
    v_cvt_pk_bf16_f32 v94, v57, v59
    v_cvt_pk_bf16_f32 v95, v61, v63
    s_add_u32 s49, s48, 1
    s_and_b32 s49, s49, 7
    s_add_u32 m0, s47, 2048
    s_lshl_b32 s51, s49, 16
    s_add_u32 s51, s51, s53
    s_add_u32 s52, s51, 31744
    buffer_load_dwordx4 v10, s[16:19], s51 offen lds
    buffer_load_dwordx4 v10, s[16:19], s52 offen offset:1024 lds
    s_add_u32 s49, s48, 1
    s_and_b32 s49, s49, 7
    s_lshl_b32 s50, s49, 14
    s_add_u32 s50, s50, s43
    s_lshl_b32 s51, s49, 10
    s_add_u32 s52, s51, s45
    s_add_u32 s51, s51, s44
    buffer_load_dwordx4 a[16:19], v2, s[16:19], s50 offen
    s_add_u32 s50, s50, s3
    buffer_load_dwordx4 a[20:23], v2, s[16:19], s50 offen
    buffer_load_dwordx4 a[24:27], v2, s[16:19], s51 offen
    buffer_load_dwordx4 a[28:31], v2, s[16:19], s52 offen
    s_add_u32 s49, s48, 4
    s_and_b32 s49, s49, 7
    s_or_b32 s49, s49, s60
    s_cselect_b32 s54, 0, 1.0
    s_mov_b32 s55, s54
    s_lshl_b32 s49, s49, 4
    v_cvt_f32_u32 v24, s49
    s_add_u32 s57, s48, 5
    s_and_b32 s57, s57, 7
    s_or_b32 s57, s57, s60
    s_cselect_b32 s58, 0, 1.0
    s_mov_b32 s59, s58
    s_lshl_b32 s57, s57, 4
    v_cvt_f32_u32 v26, s57
    v_pk_fma_f32 v[32:33], v[16:17], v[24:25], v[20:21] op_sel_hi:[1,0,1]
    v_pk_fma_f32 v[48:49], v[16:17], v[26:27], v[20:21] op_sel_hi:[1,0,1]
    v_pk_add_f32 v[34:35], v[32:33], v[16:17]
    v_pk_add_f32 v[50:51], v[48:49], v[16:17]
    v_cos_f32 v32, v32
    v_cos_f32 v33, v33
    v_cos_f32 v34, v34
    v_cos_f32 v35, v35
    v_cos_f32 v48, v48
    v_cos_f32 v49, v49
    v_cos_f32 v50, v50
    v_cos_f32 v51, v51
    v_pk_fma_f32 v[36:37], v[18:19], v[34:35], v[32:33] neg_lo:[0,0,1] neg_hi:[0,0,1]
    v_pk_fma_f32 v[52:53], v[18:19], v[50:51], v[48:49] neg_lo:[0,0,1] neg_hi:[0,0,1]
    v_pk_fma_f32 v[32:33], v[22:23], s[54:55], v[32:33]
    v_pk_fma_f32 v[48:49], v[22:23], s[58:59], v[48:49]
    v_pk_fma_f32 v[38:39], v[18:19], v[36:37], v[34:35] neg_lo:[0,0,1] neg_hi:[0,0,1]
    v_pk_fma_f32 v[54:55], v[18:19], v[52:53], v[50:51] neg_lo:[0,0,1] neg_hi:[0,0,1]
    v_pk_fma_f32 v[40:41], v[18:19], v[38:39], v[36:37] neg_lo:[0,0,1] neg_hi:[0,0,1]
    v_pk_fma_f32 v[56:57], v[18:19], v[54:55], v[52:53] neg_lo:[0,0,1] neg_hi:[0,0,1]
    v_pk_fma_f32 v[42:43], v[18:19], v[40:41], v[38:39] neg_lo:[0,0,1] neg_hi:[0,0,1]
    v_pk_fma_f32 v[58:59], v[18:19], v[56:57], v[54:55] neg_lo:[0,0,1] neg_hi:[0,0,1]
    v_pk_fma_f32 v[44:45], v[18:19], v[42:43], v[40:41] neg_lo:[0,0,1] neg_hi:[0,0,1]
    v_pk_fma_f32 v[60:61], v[18:19], v[58:59], v[56:57] neg_lo:[0,0,1] neg_hi:[0,0,1]
    v_pk_fma_f32 v[46:47], v[18:19], v[44:45], v[42:43] neg_lo:[0,0,1] neg_hi:[0,0,1]
    v_pk_fma_f32 v[62:63], v[18:19], v[60:61], v[58:59] neg_lo:[0,0,1] neg_hi:[0,0,1]
    v_cvt_pk_bf16_f32 v96, v32, v34
    v_cvt_pk_bf16_f32 v97, v36, v38
    v_cvt_pk_bf16_f32 v98, v40, v42
    v_cvt_pk_bf16_f32 v99, v44, v46
    v_cvt_pk_bf16_f32 v100, v33, v35
    v_cvt_pk_bf16_f32 v101, v37, v39
    v_cvt_pk_bf16_f32 v102, v41, v43
    v_cvt_pk_bf16_f32 v103, v45, v47
    v_cvt_pk_bf16_f32 v104, v48, v50
    v_cvt_pk_bf16_f32 v105, v52, v54
    v_cvt_pk_bf16_f32 v106, v56, v58
    v_cvt_pk_bf16_f32 v107, v60, v62
    v_cvt_pk_bf16_f32 v108, v49, v51
    v_cvt_pk_bf16_f32 v109, v53, v55
    v_cvt_pk_bf16_f32 v110, v57, v59
    v_cvt_pk_bf16_f32 v111, v61, v63
    s_add_u32 s49, s48, 2
    s_and_b32 s49, s49, 7
    s_add_u32 m0, s47, 4096
    s_lshl_b32 s51, s49, 16
    s_add_u32 s51, s51, s53
    s_add_u32 s52, s51, 31744
    buffer_load_dwordx4 v10, s[16:19], s51 offen lds
    buffer_load_dwordx4 v10, s[16:19], s52 offen offset:1024 lds
    s_add_u32 s49, s48, 2
    s_and_b32 s49, s49, 7
    s_lshl_b32 s50, s49, 14
    s_add_u32 s50, s50, s43
    s_lshl_b32 s51, s49, 10
    s_add_u32 s52, s51, s45
    s_add_u32 s51, s51, s44
    buffer_load_dwordx4 a[32:35], v2, s[16:19], s50 offen
    s_add_u32 s50, s50, s3
    buffer_load_dwordx4 a[36:39], v2, s[16:19], s50 offen
    buffer_load_dwordx4 a[40:43], v2, s[16:19], s51 offen
    buffer_load_dwordx4 a[44:47], v2, s[16:19], s52 offen
    s_add_u32 s49, s48, 6
    s_and_b32 s49, s49, 7
    s_or_b32 s49, s49, s60
    s_cselect_b32 s54, 0, 1.0
    s_mov_b32 s55, s54
    s_lshl_b32 s49, s49, 4
    v_cvt_f32_u32 v24, s49
    s_add_u32 s57, s48, 7
    s_and_b32 s57, s57, 7
    s_or_b32 s57, s57, s60
    s_cselect_b32 s58, 0, 1.0
    s_mov_b32 s59, s58
    s_lshl_b32 s57, s57, 4
    v_cvt_f32_u32 v26, s57
    v_pk_fma_f32 v[32:33], v[16:17], v[24:25], v[20:21] op_sel_hi:[1,0,1]
    v_pk_fma_f32 v[48:49], v[16:17], v[26:27], v[20:21] op_sel_hi:[1,0,1]
    v_pk_add_f32 v[34:35], v[32:33], v[16:17]
    v_pk_add_f32 v[50:51], v[48:49], v[16:17]
    v_cos_f32 v32, v32
    v_cos_f32 v33, v33
    v_cos_f32 v34, v34
    v_cos_f32 v35, v35
    v_cos_f32 v48, v48
    v_cos_f32 v49, v49
    v_cos_f32 v50, v50
    v_cos_f32 v51, v51
    v_pk_fma_f32 v[36:37], v[18:19], v[34:35], v[32:33] neg_lo:[0,0,1] neg_hi:[0,0,1]
    v_pk_fma_f32 v[52:53], v[18:19], v[50:51], v[48:49] neg_lo:[0,0,1] neg_hi:[0,0,1]
    v_pk_fma_f32 v[32:33], v[22:23], s[54:55], v[32:33]
    v_pk_fma_f32 v[48:49], v[22:23], s[58:59], v[48:49]
    v_pk_fma_f32 v[38:39], v[18:19], v[36:37], v[34:35] neg_lo:[0,0,1] neg_hi:[0,0,1]
    v_pk_fma_f32 v[54:55], v[18:19], v[52:53], v[50:51] neg_lo:[0,0,1] neg_hi:[0,0,1]
    v_pk_fma_f32 v[40:41], v[18:19], v[38:39], v[36:37] neg_lo:[0,0,1] neg_hi:[0,0,1]
    v_pk_fma_f32 v[56:57], v[18:19], v[54:55], v[52:53] neg_lo:[0,0,1] neg_hi:[0,0,1]
    v_pk_fma_f32 v[42:43], v[18:19], v[40:41], v[38:39] neg_lo:[0,0,1] neg_hi:[0,0,1]
    v_pk_fma_f32 v[58:59], v[18:19], v[56:57], v[54:55] neg_lo:[0,0,1] neg_hi:[0,0,1]
    v_pk_fma_f32 v[44:45], v[18:19], v[42:43], v[40:41] neg_lo:[0,0,1] neg_hi:[0,0,1]
    v_pk_fma_f32 v[60:61], v[18:19], v[58:59], v[56:57] neg_lo:[0,0,1] neg_hi:[0,0,1]
    v_pk_fma_f32 v[46:47], v[18:19], v[44:45], v[42:43] neg_lo:[0,0,1] neg_hi:[0,0,1]
    v_pk_fma_f32 v[62:63], v[18:19], v[60:61], v[58:59] neg_lo:[0,0,1] neg_hi:[0,0,1]
    v_cvt_pk_bf16_f32 v112, v32, v34
    v_cvt_pk_bf16_f32 v113, v36, v38
    v_cvt_pk_bf16_f32 v114, v40, v42
    v_cvt_pk_bf16_f32 v115, v44, v46
    v_cvt_pk_bf16_f32 v116, v33, v35
    v_cvt_pk_bf16_f32 v117, v37, v39
    v_cvt_pk_bf16_f32 v118, v41, v43
    v_cvt_pk_bf16_f32 v119, v45, v47
    v_cvt_pk_bf16_f32 v120, v48, v50
    v_cvt_pk_bf16_f32 v121, v52, v54
    v_cvt_pk_bf16_f32 v122, v56, v58
    v_cvt_pk_bf16_f32 v123, v60, v62
    v_cvt_pk_bf16_f32 v124, v49, v51
    v_cvt_pk_bf16_f32 v125, v53, v55
    v_cvt_pk_bf16_f32 v126, v57, v59
    v_cvt_pk_bf16_f32 v127, v61, v63
    v_bfe_u32 v11, v1, 2, 2
    v_lshrrev_b32 v12, 5, v1
    v_lshl_add_u32 v12, v12, 3, v11
    v_lshlrev_b32 v12, 7, v12
    v_bfe_u32 v13, v1, 4, 1
    v_lshl_add_u32 v12, v13, 5, v12
    v_and_b32 v13, 3, v1
    v_lshl_add_u32 v12, v13, 3, v12
    v_lshrrev_b32 v11, 1, v11
    v_lshl_add_u32 v8, v11, 6, v12
    v_add_u32 v8, s47, v8
    s_lshl_b32 s46, s63, 6
    v_xor_b32 v8, s46, v8
    v_xor_b32 v9, 64, v8
    s_xor_b32 s46, s40, 1
    s_mul_i32 s46, s46, 12288
    s_add_u32 s46, s46, 65536
    v_add_u32 v61, s46, v2
    s_xor_b32 s46, s40, 2
    s_mul_i32 s46, s46, 12288
    s_add_u32 s46, s46, 69632
    v_add_u32 v62, s46, v2
    s_xor_b32 s46, s40, 3
    s_mul_i32 s46, s46, 12288
    s_add_u32 s46, s46, 73728
    v_add_u32 v63, s46, v2
    s_mul_i32 s46, s40, 12288
    s_add_u32 s46, s46, 65536
    v_add_u32 v12, s46, v2
    s_mov_b32 s24, s4
    s_mov_b32 s25, s5
    s_mov_b32 s26, 2097152
    s_mov_b32 s27, 0x00020000
    v_and_b32 v13, 31, v1
    v_lshlrev_b32 v15, 3, v13
    s_lshl_b32 s46, s63, 8
    v_add_u32 v15, s46, v15
    v_xor_b32 v3, 256, v15
    v_lshrrev_b32 v14, 5, v1
    v_lshlrev_b32 v14, 5, v14
    v_lshl_add_u32 v13, v13, 10, v14
    s_lshl_b32 s61, s41, 16
    s_and_b32 s46, s40, 1
    s_lshl_b32 s46, s46, 15
    s_add_u32 s61, s61, s46
    s_lshl_b32 s46, s42, 7
    s_add_u32 s61, s61, s46
    s_lshr_b32 s46, s40, 1
    s_lshl_b32 s46, s46, 6
    s_add_u32 s61, s61, s46
    s_lshl_b32 s46, s41, 9
    s_add_u32 s46, s46, 14680064
    s_waitcnt vmcnt(16)
    ds_read_b64_tr_b16 v[16:17], v8 offset:0
    ds_read_b64_tr_b16 v[18:19], v8 offset:512
    ds_read_b64_tr_b16 v[20:21], v9 offset:0
    ds_read_b64_tr_b16 v[22:23], v9 offset:512
    s_waitcnt vmcnt(12)
    v_mfma_f32_32x32x16_bf16 v[128:143], a[0:3], a[8:11], 0
    v_mfma_f32_32x32x16_bf16 v[144:159], a[0:3], a[12:15], 0
    v_mfma_f32_32x32x16_bf16 v[160:175], a[4:7], a[8:11], 0
    v_mfma_f32_32x32x16_bf16 v[176:191], a[4:7], a[12:15], 0
    s_add_u32 s49, s48, 3
    s_and_b32 s49, s49, 7
    s_add_u32 m0, s47, 6144
    s_lshl_b32 s51, s49, 16
    s_add_u32 s51, s51, s53
    s_add_u32 s52, s51, 31744
    buffer_load_dwordx4 v10, s[16:19], s51 offen lds
    buffer_load_dwordx4 v10, s[16:19], s52 offen offset:1024 lds
    s_waitcnt vmcnt(12)
    ds_read_b64_tr_b16 v[24:25], v8 offset:2048
    ds_read_b64_tr_b16 v[26:27], v8 offset:2560
    ds_read_b64_tr_b16 v[28:29], v9 offset:2048
    ds_read_b64_tr_b16 v[30:31], v9 offset:2560
    s_waitcnt lgkmcnt(4)
    v_mfma_f32_32x32x16_bf16 v[192:207], v[64:67], v[16:19], 0
    v_mfma_f32_32x32x16_bf16 v[208:223], v[64:67], v[20:23], 0
    v_mfma_f32_32x32x16_bf16 v[224:239], v[68:71], v[16:19], 0
    v_mfma_f32_32x32x16_bf16 v[240:255], v[68:71], v[20:23], 0
    s_add_u32 s49, s48, 3
    s_and_b32 s49, s49, 7
    s_lshl_b32 s50, s49, 14
    s_add_u32 s50, s50, s43
    s_lshl_b32 s51, s49, 10
    s_add_u32 s52, s51, s45
    s_add_u32 s51, s51, s44
    buffer_load_dwordx4 a[48:51], v2, s[16:19], s50 offen
    s_add_u32 s50, s50, s3
    buffer_load_dwordx4 a[52:55], v2, s[16:19], s50 offen
    buffer_load_dwordx4 a[56:59], v2, s[16:19], s51 offen
    buffer_load_dwordx4 a[60:63], v2, s[16:19], s52 offen
    s_waitcnt vmcnt(12)
    v_mfma_f32_32x32x16_bf16 v[128:143], a[16:19], a[24:27], v[128:143]
    v_mfma_f32_32x32x16_bf16 v[144:159], a[16:19], a[28:31], v[144:159]
    v_mfma_f32_32x32x16_bf16 v[160:175], a[20:23], a[24:27], v[160:175]
    v_mfma_f32_32x32x16_bf16 v[176:191], a[20:23], a[28:31], v[176:191]
    s_add_u32 s49, s48, 4
    s_and_b32 s49, s49, 7
    s_add_u32 m0, s47, 8192
    s_lshl_b32 s51, s49, 16
    s_add_u32 s51, s51, s53
    s_add_u32 s52, s51, 31744
    buffer_load_dwordx4 v10, s[16:19], s51 offen lds
    buffer_load_dwordx4 v10, s[16:19], s52 offen offset:1024 lds
    s_waitcnt vmcnt(12)
    ds_read_b64_tr_b16 v[16:17], v8 offset:4096
    ds_read_b64_tr_b16 v[18:19], v8 offset:4608
    ds_read_b64_tr_b16 v[20:21], v9 offset:4096
    ds_read_b64_tr_b16 v[22:23], v9 offset:4608
    s_waitcnt lgkmcnt(4)
    v_mfma_f32_32x32x16_bf16 v[192:207], v[72:75], v[24:27], v[192:207]
    v_mfma_f32_32x32x16_bf16 v[208:223], v[72:75], v[28:31], v[208:223]
    v_mfma_f32_32x32x16_bf16 v[224:239], v[76:79], v[24:27], v[224:239]
    v_mfma_f32_32x32x16_bf16 v[240:255], v[76:79], v[28:31], v[240:255]
    s_add_u32 s49, s48, 4
    s_and_b32 s49, s49, 7
    s_lshl_b32 s50, s49, 14
    s_add_u32 s50, s50, s43
    s_lshl_b32 s51, s49, 10
    s_add_u32 s52, s51, s45
    s_add_u32 s51, s51, s44
    buffer_load_dwordx4 a[64:67], v2, s[16:19], s50 offen
    s_add_u32 s50, s50, s3
    buffer_load_dwordx4 a[68:71], v2, s[16:19], s50 offen
    buffer_load_dwordx4 a[72:75], v2, s[16:19], s51 offen
    buffer_load_dwordx4 a[76:79], v2, s[16:19], s52 offen
    s_waitcnt vmcnt(12)
    v_mfma_f32_32x32x16_bf16 v[128:143], a[32:35], a[40:43], v[128:143]
    v_mfma_f32_32x32x16_bf16 v[144:159], a[32:35], a[44:47], v[144:159]
    v_mfma_f32_32x32x16_bf16 v[160:175], a[36:39], a[40:43], v[160:175]
    v_mfma_f32_32x32x16_bf16 v[176:191], a[36:39], a[44:47], v[176:191]
    s_add_u32 s49, s48, 5
    s_and_b32 s49, s49, 7
    s_add_u32 m0, s47, 10240
    s_lshl_b32 s51, s49, 16
    s_add_u32 s51, s51, s53
    s_add_u32 s52, s51, 31744
    buffer_load_dwordx4 v10, s[16:19], s51 offen lds
    buffer_load_dwordx4 v10, s[16:19], s52 offen offset:1024 lds
    s_waitcnt vmcnt(12)
    ds_read_b64_tr_b16 v[24:25], v8 offset:6144
    ds_read_b64_tr_b16 v[26:27], v8 offset:6656
    ds_read_b64_tr_b16 v[28:29], v9 offset:6144
    ds_read_b64_tr_b16 v[30:31], v9 offset:6656
    s_waitcnt lgkmcnt(4)
    v_mfma_f32_32x32x16_bf16 v[192:207], v[80:83], v[16:19], v[192:207]
    v_mfma_f32_32x32x16_bf16 v[208:223], v[80:83], v[20:23], v[208:223]
    v_mfma_f32_32x32x16_bf16 v[224:239], v[84:87], v[16:19], v[224:239]
    v_mfma_f32_32x32x16_bf16 v[240:255], v[84:87], v[20:23], v[240:255]
    s_add_u32 s49, s48, 5
    s_and_b32 s49, s49, 7
    s_lshl_b32 s50, s49, 14
    s_add_u32 s50, s50, s43
    s_lshl_b32 s51, s49, 10
    s_add_u32 s52, s51, s45
    s_add_u32 s51, s51, s44
    buffer_load_dwordx4 a[80:83], v2, s[16:19], s50 offen
    s_add_u32 s50, s50, s3
    buffer_load_dwordx4 a[84:87], v2, s[16:19], s50 offen
    buffer_load_dwordx4 a[88:91], v2, s[16:19], s51 offen
    buffer_load_dwordx4 a[92:95], v2, s[16:19], s52 offen
    s_waitcnt vmcnt(12)
    v_mfma_f32_32x32x16_bf16 v[128:143], a[48:51], a[56:59], v[128:143]
    v_mfma_f32_32x32x16_bf16 v[144:159], a[48:51], a[60:63], v[144:159]
    v_mfma_f32_32x32x16_bf16 v[160:175], a[52:55], a[56:59], v[160:175]
    v_mfma_f32_32x32x16_bf16 v[176:191], a[52:55], a[60:63], v[176:191]
    s_add_u32 s49, s48, 6
    s_and_b32 s49, s49, 7
    s_add_u32 m0, s47, 12288
    s_lshl_b32 s51, s49, 16
    s_add_u32 s51, s51, s53
    s_add_u32 s52, s51, 31744
    buffer_load_dwordx4 v10, s[16:19], s51 offen lds
    buffer_load_dwordx4 v10, s[16:19], s52 offen offset:1024 lds
    s_waitcnt vmcnt(12)
    ds_read_b64_tr_b16 v[16:17], v8 offset:8192
    ds_read_b64_tr_b16 v[18:19], v8 offset:8704
    ds_read_b64_tr_b16 v[20:21], v9 offset:8192
    ds_read_b64_tr_b16 v[22:23], v9 offset:8704
    s_waitcnt lgkmcnt(4)
    v_mfma_f32_32x32x16_bf16 v[192:207], v[88:91], v[24:27], v[192:207]
    v_mfma_f32_32x32x16_bf16 v[208:223], v[88:91], v[28:31], v[208:223]
    v_mfma_f32_32x32x16_bf16 v[224:239], v[92:95], v[24:27], v[224:239]
    v_mfma_f32_32x32x16_bf16 v[240:255], v[92:95], v[28:31], v[240:255]
    s_add_u32 s49, s48, 6
    s_and_b32 s49, s49, 7
    s_lshl_b32 s50, s49, 14
    s_add_u32 s50, s50, s43
    s_lshl_b32 s51, s49, 10
    s_add_u32 s52, s51, s45
    s_add_u32 s51, s51, s44
    buffer_load_dwordx4 a[96:99], v2, s[16:19], s50 offen
    s_add_u32 s50, s50, s3
    buffer_load_dwordx4 a[100:103], v2, s[16:19], s50 offen
    buffer_load_dwordx4 a[104:107], v2, s[16:19], s51 offen
    buffer_load_dwordx4 a[108:111], v2, s[16:19], s52 offen
    s_waitcnt vmcnt(12)
    v_mfma_f32_32x32x16_bf16 v[128:143], a[64:67], a[72:75], v[128:143]
    v_mfma_f32_32x32x16_bf16 v[144:159], a[64:67], a[76:79], v[144:159]
    v_mfma_f32_32x32x16_bf16 v[160:175], a[68:71], a[72:75], v[160:175]
    v_mfma_f32_32x32x16_bf16 v[176:191], a[68:71], a[76:79], v[176:191]
    s_add_u32 s49, s48, 7
    s_and_b32 s49, s49, 7
    s_add_u32 m0, s47, 14336
    s_lshl_b32 s51, s49, 16
    s_add_u32 s51, s51, s53
    s_add_u32 s52, s51, 31744
    buffer_load_dwordx4 v10, s[16:19], s51 offen lds
    buffer_load_dwordx4 v10, s[16:19], s52 offen offset:1024 lds
    s_waitcnt vmcnt(12)
    ds_read_b64_tr_b16 v[24:25], v8 offset:10240
    ds_read_b64_tr_b16 v[26:27], v8 offset:10752
    ds_read_b64_tr_b16 v[28:29], v9 offset:10240
    ds_read_b64_tr_b16 v[30:31], v9 offset:10752
    s_waitcnt lgkmcnt(4)
    v_mfma_f32_32x32x16_bf16 v[192:207], v[96:99], v[16:19], v[192:207]
    v_mfma_f32_32x32x16_bf16 v[208:223], v[96:99], v[20:23], v[208:223]
    v_mfma_f32_32x32x16_bf16 v[224:239], v[100:103], v[16:19], v[224:239]
    v_mfma_f32_32x32x16_bf16 v[240:255], v[100:103], v[20:23], v[240:255]
    s_add_u32 s49, s48, 7
    s_and_b32 s49, s49, 7
    s_lshl_b32 s50, s49, 14
    s_add_u32 s50, s50, s43
    s_lshl_b32 s51, s49, 10
    s_add_u32 s52, s51, s45
    s_add_u32 s51, s51, s44
    buffer_load_dwordx4 a[112:115], v2, s[16:19], s50 offen
    s_add_u32 s50, s50, s3
    buffer_load_dwordx4 a[116:119], v2, s[16:19], s50 offen
    buffer_load_dwordx4 a[120:123], v2, s[16:19], s51 offen
    buffer_load_dwordx4 a[124:127], v2, s[16:19], s52 offen
    buffer_load_dwordx2 v[4:5], v15, s[16:19], s46 offen
    buffer_load_dwordx2 v[6:7], v3, s[16:19], s46 offen
    s_waitcnt vmcnt(14)
    v_mfma_f32_32x32x16_bf16 v[128:143], a[80:83], a[88:91], v[128:143]
    v_mfma_f32_32x32x16_bf16 v[144:159], a[80:83], a[92:95], v[144:159]
    v_mfma_f32_32x32x16_bf16 v[160:175], a[84:87], a[88:91], v[160:175]
    v_mfma_f32_32x32x16_bf16 v[176:191], a[84:87], a[92:95], v[176:191]
    s_waitcnt vmcnt(12)
    ds_read_b64_tr_b16 v[16:17], v8 offset:12288
    ds_read_b64_tr_b16 v[18:19], v8 offset:12800
    ds_read_b64_tr_b16 v[20:21], v9 offset:12288
    ds_read_b64_tr_b16 v[22:23], v9 offset:12800
    s_waitcnt lgkmcnt(4)
    v_mfma_f32_32x32x16_bf16 v[192:207], v[104:107], v[24:27], v[192:207]
    v_mfma_f32_32x32x16_bf16 v[208:223], v[104:107], v[28:31], v[208:223]
    v_mfma_f32_32x32x16_bf16 v[224:239], v[108:111], v[24:27], v[224:239]
    v_mfma_f32_32x32x16_bf16 v[240:255], v[108:111], v[28:31], v[240:255]
    s_waitcnt vmcnt(8)
    v_mfma_f32_32x32x16_bf16 v[128:143], a[96:99], a[104:107], v[128:143]
    v_mfma_f32_32x32x16_bf16 v[144:159], a[96:99], a[108:111], v[144:159]
    v_mfma_f32_32x32x16_bf16 v[160:175], a[100:103], a[104:107], v[160:175]
    v_mfma_f32_32x32x16_bf16 v[176:191], a[100:103], a[108:111], v[176:191]
    s_waitcnt vmcnt(6)
    ds_read_b64_tr_b16 v[24:25], v8 offset:14336
    ds_read_b64_tr_b16 v[26:27], v8 offset:14848
    ds_read_b64_tr_b16 v[28:29], v9 offset:14336
    ds_read_b64_tr_b16 v[30:31], v9 offset:14848
    s_waitcnt lgkmcnt(4)
    v_mfma_f32_32x32x16_bf16 v[192:207], v[112:115], v[16:19], v[192:207]
    v_mfma_f32_32x32x16_bf16 v[208:223], v[112:115], v[20:23], v[208:223]
    v_mfma_f32_32x32x16_bf16 v[224:239], v[116:119], v[16:19], v[224:239]
    v_mfma_f32_32x32x16_bf16 v[240:255], v[116:119], v[20:23], v[240:255]
    s_waitcnt vmcnt(2)
    v_mfma_f32_32x32x16_bf16 v[128:143], a[112:115], a[120:123], v[128:143]
    v_mfma_f32_32x32x16_bf16 v[144:159], a[112:115], a[124:127], v[144:159]
    v_mfma_f32_32x32x16_bf16 v[160:175], a[116:119], a[120:123], v[160:175]
    v_mfma_f32_32x32x16_bf16 v[176:191], a[116:119], a[124:127], v[176:191]
    s_waitcnt lgkmcnt(0)
    v_mfma_f32_32x32x16_bf16 v[192:207], v[120:123], v[24:27], v[192:207]
    v_mfma_f32_32x32x16_bf16 v[208:223], v[120:123], v[28:31], v[208:223]
    v_mfma_f32_32x32x16_bf16 v[224:239], v[124:127], v[24:27], v[224:239]
    v_mfma_f32_32x32x16_bf16 v[240:255], v[124:127], v[28:31], v[240:255]
    s_waitcnt vmcnt(0)
    s_nop 3
    v_pk_mul_f32 v[144:145], v[144:145], v[6:7] op_sel_hi:[1,0]
    v_pk_mul_f32 v[146:147], v[146:147], v[6:7] op_sel_hi:[1,0]
    v_pk_mul_f32 v[148:149], v[148:149], v[6:7] op_sel_hi:[1,0]
    v_pk_mul_f32 v[150:151], v[150:151], v[6:7] op_sel_hi:[1,0]
    v_pk_mul_f32 v[152:153], v[152:153], v[6:7] op_sel_hi:[1,0]
    v_pk_mul_f32 v[154:155], v[154:155], v[6:7] op_sel_hi:[1,0]
    v_pk_mul_f32 v[156:157], v[156:157], v[6:7] op_sel_hi:[1,0]
    v_pk_mul_f32 v[158:159], v[158:159], v[6:7] op_sel_hi:[1,0]
    v_pk_fma_f32 v[144:145], v[208:209], v[6:7], v[144:145] op_sel:[0,1,0]
    v_pk_fma_f32 v[146:147], v[210:211], v[6:7], v[146:147] op_sel:[0,1,0]
    ds_write_b128 v61, v[144:147] offset:0
    v_pk_fma_f32 v[148:149], v[212:213], v[6:7], v[148:149] op_sel:[0,1,0]
    v_pk_fma_f32 v[150:151], v[214:215], v[6:7], v[150:151] op_sel:[0,1,0]
    ds_write_b128 v61, v[148:151] offset:1024
    v_pk_fma_f32 v[152:153], v[216:217], v[6:7], v[152:153] op_sel:[0,1,0]
    v_pk_fma_f32 v[154:155], v[218:219], v[6:7], v[154:155] op_sel:[0,1,0]
    ds_write_b128 v61, v[152:155] offset:2048
    v_pk_fma_f32 v[156:157], v[220:221], v[6:7], v[156:157] op_sel:[0,1,0]
    v_pk_fma_f32 v[158:159], v[222:223], v[6:7], v[158:159] op_sel:[0,1,0]
    ds_write_b128 v61, v[156:159] offset:3072
    v_pk_mul_f32 v[160:161], v[160:161], v[4:5] op_sel_hi:[1,0]
    v_pk_mul_f32 v[162:163], v[162:163], v[4:5] op_sel_hi:[1,0]
    v_pk_mul_f32 v[164:165], v[164:165], v[4:5] op_sel_hi:[1,0]
    v_pk_mul_f32 v[166:167], v[166:167], v[4:5] op_sel_hi:[1,0]
    v_pk_mul_f32 v[168:169], v[168:169], v[4:5] op_sel_hi:[1,0]
    v_pk_mul_f32 v[170:171], v[170:171], v[4:5] op_sel_hi:[1,0]
    v_pk_mul_f32 v[172:173], v[172:173], v[4:5] op_sel_hi:[1,0]
    v_pk_mul_f32 v[174:175], v[174:175], v[4:5] op_sel_hi:[1,0]
    v_pk_fma_f32 v[160:161], v[224:225], v[4:5], v[160:161] op_sel:[0,1,0]
    v_pk_fma_f32 v[162:163], v[226:227], v[4:5], v[162:163] op_sel:[0,1,0]
    ds_write_b128 v62, v[160:163] offset:0
    v_pk_fma_f32 v[164:165], v[228:229], v[4:5], v[164:165] op_sel:[0,1,0]
    v_pk_fma_f32 v[166:167], v[230:231], v[4:5], v[166:167] op_sel:[0,1,0]
    ds_write_b128 v62, v[164:167] offset:1024
    v_pk_fma_f32 v[168:169], v[232:233], v[4:5], v[168:169] op_sel:[0,1,0]
    v_pk_fma_f32 v[170:171], v[234:235], v[4:5], v[170:171] op_sel:[0,1,0]
    ds_write_b128 v62, v[168:171] offset:2048
    v_pk_fma_f32 v[172:173], v[236:237], v[4:5], v[172:173] op_sel:[0,1,0]
    v_pk_fma_f32 v[174:175], v[238:239], v[4:5], v[174:175] op_sel:[0,1,0]
    ds_write_b128 v62, v[172:175] offset:3072
    v_pk_mul_f32 v[176:177], v[176:177], v[6:7] op_sel_hi:[1,0]
    v_pk_mul_f32 v[178:179], v[178:179], v[6:7] op_sel_hi:[1,0]
    v_pk_mul_f32 v[180:181], v[180:181], v[6:7] op_sel_hi:[1,0]
    v_pk_mul_f32 v[182:183], v[182:183], v[6:7] op_sel_hi:[1,0]
    v_pk_mul_f32 v[184:185], v[184:185], v[6:7] op_sel_hi:[1,0]
    v_pk_mul_f32 v[186:187], v[186:187], v[6:7] op_sel_hi:[1,0]
    v_pk_mul_f32 v[188:189], v[188:189], v[6:7] op_sel_hi:[1,0]
    v_pk_mul_f32 v[190:191], v[190:191], v[6:7] op_sel_hi:[1,0]
    v_pk_fma_f32 v[176:177], v[240:241], v[6:7], v[176:177] op_sel:[0,1,0]
    v_pk_fma_f32 v[178:179], v[242:243], v[6:7], v[178:179] op_sel:[0,1,0]
    ds_write_b128 v63, v[176:179] offset:0
    v_pk_fma_f32 v[180:181], v[244:245], v[6:7], v[180:181] op_sel:[0,1,0]
    v_pk_fma_f32 v[182:183], v[246:247], v[6:7], v[182:183] op_sel:[0,1,0]
    ds_write_b128 v63, v[180:183] offset:1024
    v_pk_fma_f32 v[184:185], v[248:249], v[6:7], v[184:185] op_sel:[0,1,0]
    v_pk_fma_f32 v[186:187], v[250:251], v[6:7], v[186:187] op_sel:[0,1,0]
    ds_write_b128 v63, v[184:187] offset:2048
    v_pk_fma_f32 v[188:189], v[252:253], v[6:7], v[188:189] op_sel:[0,1,0]
    v_pk_fma_f32 v[190:191], v[254:255], v[6:7], v[190:191] op_sel:[0,1,0]
    ds_write_b128 v63, v[188:191] offset:3072
    v_pk_mul_f32 v[128:129], v[128:129], v[4:5] op_sel_hi:[1,0]
    v_pk_mul_f32 v[130:131], v[130:131], v[4:5] op_sel_hi:[1,0]
    v_pk_mul_f32 v[132:133], v[132:133], v[4:5] op_sel_hi:[1,0]
    v_pk_mul_f32 v[134:135], v[134:135], v[4:5] op_sel_hi:[1,0]
    v_pk_mul_f32 v[136:137], v[136:137], v[4:5] op_sel_hi:[1,0]
    v_pk_mul_f32 v[138:139], v[138:139], v[4:5] op_sel_hi:[1,0]
    v_pk_mul_f32 v[140:141], v[140:141], v[4:5] op_sel_hi:[1,0]
    v_pk_mul_f32 v[142:143], v[142:143], v[4:5] op_sel_hi:[1,0]
    v_pk_fma_f32 v[128:129], v[192:193], v[4:5], v[128:129] op_sel:[0,1,0]
    v_pk_fma_f32 v[130:131], v[194:195], v[4:5], v[130:131] op_sel:[0,1,0]
    v_pk_fma_f32 v[132:133], v[196:197], v[4:5], v[132:133] op_sel:[0,1,0]
    v_pk_fma_f32 v[134:135], v[198:199], v[4:5], v[134:135] op_sel:[0,1,0]
    v_pk_fma_f32 v[136:137], v[200:201], v[4:5], v[136:137] op_sel:[0,1,0]
    v_pk_fma_f32 v[138:139], v[202:203], v[4:5], v[138:139] op_sel:[0,1,0]
    v_pk_fma_f32 v[140:141], v[204:205], v[4:5], v[140:141] op_sel:[0,1,0]
    v_pk_fma_f32 v[142:143], v[206:207], v[4:5], v[142:143] op_sel:[0,1,0]
    s_waitcnt lgkmcnt(0)
    s_barrier
    ds_read_b128 v[64:67], v12 offset:0
    ds_read_b128 v[68:71], v12 offset:1024
    ds_read_b128 v[72:75], v12 offset:2048
    ds_read_b128 v[76:79], v12 offset:3072
    ds_read_b128 v[80:83], v12 offset:4096
    ds_read_b128 v[84:87], v12 offset:5120
    ds_read_b128 v[88:91], v12 offset:6144
    ds_read_b128 v[92:95], v12 offset:7168
    ds_read_b128 v[96:99], v12 offset:8192
    ds_read_b128 v[100:103], v12 offset:9216
    ds_read_b128 v[104:107], v12 offset:10240
    ds_read_b128 v[108:111], v12 offset:11264
    s_waitcnt lgkmcnt(8)
    v_pk_add_f32 v[64:65], v[64:65], v[128:129]
    v_pk_add_f32 v[66:67], v[66:67], v[130:131]
    v_pk_add_f32 v[68:69], v[68:69], v[132:133]
    v_pk_add_f32 v[70:71], v[70:71], v[134:135]
    v_pk_add_f32 v[72:73], v[72:73], v[136:137]
    v_pk_add_f32 v[74:75], v[74:75], v[138:139]
    v_pk_add_f32 v[76:77], v[76:77], v[140:141]
    v_pk_add_f32 v[78:79], v[78:79], v[142:143]
    s_waitcnt lgkmcnt(0)
    v_pk_add_f32 v[96:97], v[96:97], v[80:81]
    v_pk_add_f32 v[98:99], v[98:99], v[82:83]
    v_pk_add_f32 v[100:101], v[100:101], v[84:85]
    v_pk_add_f32 v[102:103], v[102:103], v[86:87]
    v_pk_add_f32 v[104:105], v[104:105], v[88:89]
    v_pk_add_f32 v[106:107], v[106:107], v[90:91]
    v_pk_add_f32 v[108:109], v[108:109], v[92:93]
    v_pk_add_f32 v[110:111], v[110:111], v[94:95]
    v_pk_add_f32 v[64:65], v[64:65], v[96:97]
    v_pk_add_f32 v[66:67], v[66:67], v[98:99]
    v_pk_add_f32 v[68:69], v[68:69], v[100:101]
    v_pk_add_f32 v[70:71], v[70:71], v[102:103]
    v_pk_add_f32 v[72:73], v[72:73], v[104:105]
    v_pk_add_f32 v[74:75], v[74:75], v[106:107]
    v_pk_add_f32 v[76:77], v[76:77], v[108:109]
    v_pk_add_f32 v[78:79], v[78:79], v[110:111]
    v_cvt_pk_bf16_f32 v80, v64, v65
    v_cvt_pk_bf16_f32 v81, v66, v67
    v_cvt_pk_bf16_f32 v82, v68, v69
    v_cvt_pk_bf16_f32 v83, v70, v71
    v_cvt_pk_bf16_f32 v84, v72, v73
    v_cvt_pk_bf16_f32 v85, v74, v75
    v_cvt_pk_bf16_f32 v86, v76, v77
    v_cvt_pk_bf16_f32 v87, v78, v79
    buffer_store_dwordx4 v[80:83], v13, s[24:27], s61 offen
    buffer_store_dwordx4 v[84:87], v13, s[24:27], s61 offen offset:16
k3_end:
    s_endpgm
k3_code_end:

.section .rodata,"a"
.p2align 6
.amdhsa_kernel k1_kernel
  .amdhsa_next_free_vgpr 212
  .amdhsa_next_free_sgpr 100
  .amdhsa_accum_offset 212
  .amdhsa_group_segment_fixed_size 0
  .amdhsa_kernarg_size 80
  .amdhsa_user_sgpr_count 2
  .amdhsa_user_sgpr_kernarg_segment_ptr 1
  .amdhsa_system_sgpr_workgroup_id_x 1
  .amdhsa_float_denorm_mode_32 3
.end_amdhsa_kernel
.p2align 6
.amdhsa_kernel k2_kernel
  .amdhsa_next_free_vgpr 208
  .amdhsa_next_free_sgpr 100
  .amdhsa_accum_offset 208
  .amdhsa_group_segment_fixed_size 0
  .amdhsa_kernarg_size 80
  .amdhsa_user_sgpr_count 2
  .amdhsa_user_sgpr_kernarg_segment_ptr 1
  .amdhsa_system_sgpr_workgroup_id_x 1
  .amdhsa_float_denorm_mode_32 3
.end_amdhsa_kernel
.p2align 6
.amdhsa_kernel k3_kernel
  .amdhsa_next_free_vgpr 512
  .amdhsa_next_free_sgpr 100
  .amdhsa_accum_offset 256
  .amdhsa_group_segment_fixed_size 0
  .amdhsa_kernarg_size 80
  .amdhsa_user_sgpr_count 2
  .amdhsa_user_sgpr_kernarg_segment_ptr 1
  .amdhsa_system_sgpr_workgroup_id_x 1
  .amdhsa_float_denorm_mode_32 3
.end_amdhsa_kernel
.set CT0, 16256
.set CT1, 16256
.set CT2, 16256
.set CT3, 16256
.set CT4, 16256
.set CT5, 16256
.set CT6, 16255
.set CT7, 16255
.set CT8, 16255
.set CT9, 16254
.set CT10, 16254
.set CT11, 16254
.set CT12, 16253
.set CT13, 16253
.set CT14, 16252
.set CT15, 16252
.set CT16, 16251
.set CT17, 16250
.set CT18, 16250
.set CT19, 16249
.set CT20, 16248
.set CT21, 16248
.set CT22, 16247
.set CT23, 16246
.set CT24, 16245
.set CT25, 16244
.set CT26, 16243
.set CT27, 16242
.set CT28, 16241
.set CT29, 16240
.set CT30, 16239
.set CT31, 16238
.set CT32, 16237
.set CT33, 16235
.set CT34, 16234
.set CT35, 16233
.set CT36, 16231
.set CT37, 16230
.set CT38, 16229
.set CT39, 16227
.set CT40, 16226
.set CT41, 16224
.set CT42, 16223
.set CT43, 16221
.set CT44, 16220
.set CT45, 16218
.set CT46, 16216
.set CT47, 16215
.set CT48, 16213
.set CT49, 16211
.set CT50, 16209
.set CT51, 16207
.set CT52, 16206
.set CT53, 16204
.set CT54, 16202
.set CT55, 16200
.set CT56, 16198
.set CT57, 16196
.set CT58, 16194
.set CT59, 16192
.set CT60, 16190
.set CT61, 16188
.set CT62, 16185
.set CT63, 16183
.set CT64, 16181
.set CT65, 16179
.set CT66, 16177
.set CT67, 16174
.set CT68, 16172
.set CT69, 16170
.set CT70, 16167
.set CT71, 16165
.set CT72, 16162
.set CT73, 16160
.set CT74, 16157
.set CT75, 16155
.set CT76, 16152
.set CT77, 16150
.set CT78, 16147
.set CT79, 16145
.set CT80, 16142
.set CT81, 16140
.set CT82, 16137
.set CT83, 16134
.set CT84, 16132
.set CT85, 16129
.set CT86, 16124
.set CT87, 16119
.set CT88, 16113
.set CT89, 16108
.set CT90, 16102
.set CT91, 16097
.set CT92, 16091
.set CT93, 16085
.set CT94, 16079
.set CT95, 16074
.set CT96, 16068
.set CT97, 16062
.set CT98, 16056
.set CT99, 16050
.set CT100, 16044
.set CT101, 16039
.set CT102, 16033
.set CT103, 16027
.set CT104, 16021
.set CT105, 16015
.set CT106, 16009
.set CT107, 16002
.set CT108, 15993
.set CT109, 15981
.set CT110, 15968
.set CT111, 15956
.set CT112, 15944
.set CT113, 15931
.set CT114, 15919
.set CT115, 15907
.set CT116, 15894
.set CT117, 15882
.set CT118, 15867
.set CT119, 15842
.set CT120, 15817
.set CT121, 15792
.set CT122, 15767
.set CT123, 15739
.set CT124, 15689
.set CT125, 15639
.set CT126, 15561
.set CT127, 15433
.set CT128, 0
.set CT129, 48201
.set CT130, 48329
.set CT131, 48407
.set CT132, 48457
.set CT133, 48507
.set CT134, 48535
.set CT135, 48560
.set CT136, 48585
.set CT137, 48610
.set CT138, 48635
.set CT139, 48650
.set CT140, 48662
.set CT141, 48675
.set CT142, 48687
.set CT143, 48699
.set CT144, 48712
.set CT145, 48724
.set CT146, 48736
.set CT147, 48749
.set CT148, 48761
.set CT149, 48770
.set CT150, 48777
.set CT151, 48783
.set CT152, 48789
.set CT153, 48795
.set CT154, 48801
.set CT155, 48807
.set CT156, 48812
.set CT157, 48818
.set CT158, 48824
.set CT159, 48830
.set CT160, 48836
.set CT161, 48842
.set CT162, 48847
.set CT163, 48853
.set CT164, 48859
.set CT165, 48865
.set CT166, 48870
.set CT167, 48876
.set CT168, 48881
.set CT169, 48887
.set CT170, 48892
.set CT171, 48897
.set CT172, 48900
.set CT173, 48902
.set CT174, 48905
.set CT175, 48908
.set CT176, 48910
.set CT177, 48913
.set CT178, 48915
.set CT179, 48918
.set CT180, 48920
.set CT181, 48923
.set CT182, 48925
.set CT183, 48928
.set CT184, 48930
.set CT185, 48933
.set CT186, 48935
.set CT187, 48938
.set CT188, 48940
.set CT189, 48942
.set CT190, 48945
.set CT191, 48947
.set CT192, 48949
.set CT193, 48951
.set CT194, 48953
.set CT195, 48956
.set CT196, 48958
.set CT197, 48960
.set CT198, 48962
.set CT199, 48964
.set CT200, 48966
.set CT201, 48968
.set CT202, 48970
.set CT203, 48972
.set CT204, 48974
.set CT205, 48975
.set CT206, 48977
.set CT207, 48979
.set CT208, 48981
.set CT209, 48983
.set CT210, 48984
.set CT211, 48986
.set CT212, 48988
.set CT213, 48989
.set CT214, 48991
.set CT215, 48992
.set CT216, 48994
.set CT217, 48995
.set CT218, 48997
.set CT219, 48998
.set CT220, 48999
.set CT221, 49001
.set CT222, 49002
.set CT223, 49003
.set CT224, 49005
.set CT225, 49006
.set CT226, 49007
.set CT227, 49008
.set CT228, 49009
.set CT229, 49010
.set CT230, 49011
.set CT231, 49012
.set CT232, 49013
.set CT233, 49014
.set CT234, 49015
.set CT235, 49016
.set CT236, 49016
.set CT237, 49017
.set CT238, 49018
.set CT239, 49018
.set CT240, 49019
.set CT241, 49020
.set CT242, 49020
.set CT243, 49021
.set CT244, 49021
.set CT245, 49022
.set CT246, 49022
.set CT247, 49022
.set CT248, 49023
.set CT249, 49023
.set CT250, 49023
.set CT251, 49024
.set CT252, 49024
.set CT253, 49024
.set CT254, 49024
.set CT255, 49024
.set CT256, 49024
.set CT257, 49024
.set CT258, 49024
.set CT259, 49024
.set CT260, 49024
.set CT261, 49024
.set CT262, 49023
.set CT263, 49023
.set CT264, 49023
.set CT265, 49022
.set CT266, 49022
.set CT267, 49022
.set CT268, 49021
.set CT269, 49021
.set CT270, 49020
.set CT271, 49020
.set CT272, 49019
.set CT273, 49018
.set CT274, 49018
.set CT275, 49017
.set CT276, 49016
.set CT277, 49016
.set CT278, 49015
.set CT279, 49014
.set CT280, 49013
.set CT281, 49012
.set CT282, 49011
.set CT283, 49010
.set CT284, 49009
.set CT285, 49008
.set CT286, 49007
.set CT287, 49006
.set CT288, 49005
.set CT289, 49003
.set CT290, 49002
.set CT291, 49001
.set CT292, 48999
.set CT293, 48998
.set CT294, 48997
.set CT295, 48995
.set CT296, 48994
.set CT297, 48992
.set CT298, 48991
.set CT299, 48989
.set CT300, 48988
.set CT301, 48986
.set CT302, 48984
.set CT303, 48983
.set CT304, 48981
.set CT305, 48979
.set CT306, 48977
.set CT307, 48975
.set CT308, 48974
.set CT309, 48972
.set CT310, 48970
.set CT311, 48968
.set CT312, 48966
.set CT313, 48964
.set CT314, 48962
.set CT315, 48960
.set CT316, 48958
.set CT317, 48956
.set CT318, 48953
.set CT319, 48951
.set CT320, 48949
.set CT321, 48947
.set CT322, 48945
.set CT323, 48942
.set CT324, 48940
.set CT325, 48938
.set CT326, 48935
.set CT327, 48933
.set CT328, 48930
.set CT329, 48928
.set CT330, 48925
.set CT331, 48923
.set CT332, 48920
.set CT333, 48918
.set CT334, 48915
.set CT335, 48913
.set CT336, 48910
.set CT337, 48908
.set CT338, 48905
.set CT339, 48902
.set CT340, 48900
.set CT341, 48897
.set CT342, 48892
.set CT343, 48887
.set CT344, 48881
.set CT345, 48876
.set CT346, 48870
.set CT347, 48865
.set CT348, 48859
.set CT349, 48853
.set CT350, 48847
.set CT351, 48842
.set CT352, 48836
.set CT353, 48830
.set CT354, 48824
.set CT355, 48818
.set CT356, 48812
.set CT357, 48807
.set CT358, 48801
.set CT359, 48795
.set CT360, 48789
.set CT361, 48783
.set CT362, 48777
.set CT363, 48770
.set CT364, 48761
.set CT365, 48749
.set CT366, 48736
.set CT367, 48724
.set CT368, 48712
.set CT369, 48699
.set CT370, 48687
.set CT371, 48675
.set CT372, 48662
.set CT373, 48650
.set CT374, 48635
.set CT375, 48610
.set CT376, 48585
.set CT377, 48560
.set CT378, 48535
.set CT379, 48507
.set CT380, 48457
.set CT381, 48407
.set CT382, 48329
.set CT383, 48201
.set CT384, 0
.set CT385, 15433
.set CT386, 15561
.set CT387, 15639
.set CT388, 15689
.set CT389, 15739
.set CT390, 15767
.set CT391, 15792
.set CT392, 15817
.set CT393, 15842
.set CT394, 15867
.set CT395, 15882
.set CT396, 15894
.set CT397, 15907
.set CT398, 15919
.set CT399, 15931
.set CT400, 15944
.set CT401, 15956
.set CT402, 15968
.set CT403, 15981
.set CT404, 15993
.set CT405, 16002
.set CT406, 16009
.set CT407, 16015
.set CT408, 16021
.set CT409, 16027
.set CT410, 16033
.set CT411, 16039
.set CT412, 16044
.set CT413, 16050
.set CT414, 16056
.set CT415, 16062
.set CT416, 16068
.set CT417, 16074
.set CT418, 16079
.set CT419, 16085
.set CT420, 16091
.set CT421, 16097
.set CT422, 16102
.set CT423, 16108
.set CT424, 16113
.set CT425, 16119
.set CT426, 16124
.set CT427, 16129
.set CT428, 16132
.set CT429, 16134
.set CT430, 16137
.set CT431, 16140
.set CT432, 16142
.set CT433, 16145
.set CT434, 16147
.set CT435, 16150
.set CT436, 16152
.set CT437, 16155
.set CT438, 16157
.set CT439, 16160
.set CT440, 16162
.set CT441, 16165
.set CT442, 16167
.set CT443, 16170
.set CT444, 16172
.set CT445, 16174
.set CT446, 16177
.set CT447, 16179
.set CT448, 16181
.set CT449, 16183
.set CT450, 16185
.set CT451, 16188
.set CT452, 16190
.set CT453, 16192
.set CT454, 16194
.set CT455, 16196
.set CT456, 16198
.set CT457, 16200
.set CT458, 16202
.set CT459, 16204
.set CT460, 16206
.set CT461, 16207
.set CT462, 16209
.set CT463, 16211
.set CT464, 16213
.set CT465, 16215
.set CT466, 16216
.set CT467, 16218
.set CT468, 16220
.set CT469, 16221
.set CT470, 16223
.set CT471, 16224
.set CT472, 16226
.set CT473, 16227
.set CT474, 16229
.set CT475, 16230
.set CT476, 16231
.set CT477, 16233
.set CT478, 16234
.set CT479, 16235
.set CT480, 16237
.set CT481, 16238
.set CT482, 16239
.set CT483, 16240
.set CT484, 16241
.set CT485, 16242
.set CT486, 16243
.set CT487, 16244
.set CT488, 16245
.set CT489, 16246
.set CT490, 16247
.set CT491, 16248
.set CT492, 16248
.set CT493, 16249
.set CT494, 16250
.set CT495, 16250
.set CT496, 16251
.set CT497, 16252
.set CT498, 16252
.set CT499, 16253
.set CT500, 16253
.set CT501, 16254
.set CT502, 16254
.set CT503, 16254
.set CT504, 16255
.set CT505, 16255
.set CT506, 16255
.set CT507, 16256
.set CT508, 16256
.set CT509, 16256
.set CT510, 16256
.set CT511, 16256

.altmacro
.macro EM4 Z1, Z2, Z3, Z4
.quad (CT\Z1) | (CT\Z2 << 16) | (CT\Z3 << 32) | (CT\Z4 << 48)
.endm
.p2align 8
tab_F:
.set dd, 0
.rept 512
EM4 0, %((dd*256)&511), %(dd&511), %((dd+128)&511)
.set cc, 2
.rept 127
EM4 %((dd*cc)&511), %((dd*cc+128)&511), %((dd*(cc+1))&511), %((dd*(cc+1)+128)&511)
.set cc, cc+2
.endr
.set dd, dd+1
.endr
.noaltmacro
```
